```python
import torch

def _softmax(x, axis=-1):
    return torch.softmax(x, dim=axis)
def _gelu(x):
    return torch.nn.functional.gelu(x, approximate="tanh")
def _silu(x):
    return torch.nn.functional.silu(x)
def _sigmoid(x):
    return torch.sigmoid(x)
def _layernorm(x, axis=-1, eps=1e-5):
    m = x.mean(dim=axis, keepdim=True)
    v = x.var(dim=axis, keepdim=True, unbiased=False)
    return (x - m) / torch.sqrt(v + eps)
def _scatter_add(tgt, idx, src, axis=0):
    return tgt.clone().index_add_(axis, idx, src)
def _segment_sum(src, seg, n):
    out = torch.zeros((n,) + src.shape[1:], dtype=src.dtype)
    return out.index_add_(0, seg, src)
def _pad(x, pw):
    flat = tuple(v for pair in reversed(pw) for v in pair)
    return torch.nn.functional.pad(x, flat)

kernel_name = 'gated_mix__softmax_full_mha__dense_activation_silu__prompt'

def setup_inputs():

    _w = (lambda a: (lambda t: t.to(torch.bfloat16) if t.is_floating_point() else t)(torch.as_tensor(a)))
    def _A_setup():
        B, S, D = 1, 2048, 448
        return {
            "x": _w((lambda *s: torch.randn(*s, dtype=torch.bfloat16) * 0.05)(B, S, D)),
            "wqkv": _w((lambda *s: torch.randn(*s, dtype=torch.bfloat16) * 0.8)(D, 3 * D)),
            "wo": _w((lambda *s: torch.randn(*s, dtype=torch.bfloat16) * 0.05)(D, D)),
        }
    _A_in = _A_setup()

    def _B_setup():
        B, S, D, F = 1, 2048, 448, 1792
        return {
            "x": _w((lambda *s: torch.randn(*s, dtype=torch.bfloat16) * 0.05)(B, S, D)),
            "w1": _w((lambda *s: torch.randn(*s, dtype=torch.bfloat16) * 3.2)(D, F) * (D ** -0.5)),
            "w2": _w((lambda *s: torch.randn(*s, dtype=torch.bfloat16) * 0.8)(F, D) * (F ** -0.5)),
        }
    _B_in = _B_setup()

    return {
        "A_x": _A_in["x"],
        "A_wqkv": _A_in["wqkv"],
        "A_wo": _A_in["wo"],
        "B_x": _B_in["x"],
        "B_w1": _B_in["w1"],
        "B_w2": _B_in["w2"],
        "gate_w": _w((lambda *s: torch.randn(*s, dtype=torch.bfloat16) * 0.05)(448) * 16.0),
    }

def reference(A_x, A_wqkv, A_wo, B_x, B_w1, B_w2, gate_w):
    def _A_ref(x, wqkv, wo):
        B, S, D = x.shape
        H = 16; Dh = D // H
        qkv = (lambda x, *d: x.permute(*d))((x @ wqkv).reshape(B, S, 3, H, Dh), 2, 0, 3, 1, 4)
        q, k, v = qkv[0], qkv[1], qkv[2]
        scale = Dh ** -0.5
        scores = torch.einsum("bhqd,bhkd->bhqk", q, k) * scale
        p = _softmax(scores, axis=-1)
        o = torch.einsum("bhqk,bhkd->bhqd", p, v)
        return (lambda x, *d: x.permute(*d))(o, 0, 2, 1, 3).reshape(B, S, D) @ wo

    def _B_ref(x, w1, w2):
        h = torch.einsum("bsd,df->bsf", x, w1)
        h = _silu(h)
        out = torch.einsum("bsf,fd->bsd", h, w2)
        return out

    x = A_x
    g = _sigmoid((x * gate_w).sum(-1, keepdims=True))
    a = _A_ref(x, A_wqkv, A_wo)
    b = _B_ref(x, B_w1, B_w2)
    return g * a + (1 - g) * b
```

```asm
; @launch grid=(256,1,1) block=(512,1,1) lds=163840
.amdgcn_target "amdgcn-amd-amdhsa--gfx950"
.text
.globl gated_mix__softmax_full_mha__dense_activation_silu__prompt_kernel
.p2align 8
.type gated_mix__softmax_full_mha__dense_activation_silu__prompt_kernel,@function
gated_mix__softmax_full_mha__dense_activation_silu__prompt_kernel:
  s_cmp_ge_u32 s2, 256
  s_cbranch_scc1 k_end
  s_load_dwordx16 s[16:31], s[0:1], 0
  s_load_dwordx4 s[32:35], s[0:1], 64
  v_lshrrev_b32 v1, 6, v0
  v_and_b32 v0, 63, v0
  s_and_b32 s75, s2, 7
  s_lshr_b32 s76, s2, 3
  v_readfirstlane_b32 s74, v1
  s_and_b32 s72, s75, 1
  s_lshl_b32 s72, s72, 3
  s_and_b32 s3, s76, 7
  s_add_u32 s72, s72, s3
  s_lshr_b32 s73, s75, 1
  s_lshr_b32 s3, s75, 2
  s_xor_b32 s73, s73, 0
  s_lshl_b32 s73, s73, 2
  s_lshr_b32 s3, s76, 3
  s_add_u32 s73, s73, s3
  v_lshrrev_b32 v14, 3, v0
  v_mul_u32_u24 v14, 896, v14
  v_lshrrev_b32 v15, 4, v0
  v_and_b32 v1, 7, v0
  v_xor_b32 v15, v15, v1
  v_lshl_add_u32 v20, v15, 4, v14
  v_xor_b32 v15, 4, v15
  v_lshl_add_u32 v21, v15, 4, v14
  v_add_u32 v22, 12288, v20
  v_add_u32 v23, 18432, v21
  v_add_u32 v21, 6144, v21
  s_and_b32 s4, s74, 3
  s_lshl_b32 s3, s72, 7
  s_lshl_b32 s6, s4, 5
  s_add_u32 s3, s3, s6
  s_mul_i32 s5, s3, 896
  s_and_b32 s3, s73, 3
  s_lshl_b32 s3, s3, 1
  s_and_b32 s11, s72, 7
  s_add_u32 s11, s11, s3
  s_cmp_ge_u32 s11, 7
  s_cselect_b32 s3, 7, 0
  s_sub_u32 s11, s11, s3
  s_mul_i32 s11, s11, 1
  s_lshl_b32 s3, s11, 7
  s_add_u32 s5, s5, s3
  s_mov_b32 s15, s11
  s_lshl_b32 s6, s4, 12
  s_add_u32 s6, s6, 49152
  v_and_b32 v2, 31, v0
  v_lshrrev_b32 v3, 5, v0
  v_bfe_u32 v4, v0, 2, 2
  v_bfe_u32 v5, v0, 4, 1
  v_and_b32 v6, 3, v0
  v_lshlrev_b32 v7, 4, v0
  s_mul_i32 s3, s73, 56
  s_and_b32 s3, s3, -16
  v_add_u32 v1, 0, v0
  v_mul_u32_u24 v14, 43691, v1
  v_lshrrev_b32 v14, 19, v14
  v_mul_u32_u24 v15, 12, v14
  v_sub_u32 v1, v1, v15
  v_mul_u32_u24 v14, 2688, v14
  v_lshrrev_b32 v15, 2, v1
  v_mul_u32_u24 v15, 896, v15
  v_add_u32 v14, v14, v15
  v_and_b32 v1, 3, v1
  v_lshl_add_u32 v14, v1, 4, v14
  v_add_u32 v14, s3, v14
  v_subrev_u32 v16, 0, v14
  v_add_u32 v1, 64, v0
  v_mul_u32_u24 v14, 43691, v1
  v_lshrrev_b32 v14, 19, v14
  v_mul_u32_u24 v15, 12, v14
  v_sub_u32 v1, v1, v15
  v_mul_u32_u24 v14, 2688, v14
  v_lshrrev_b32 v15, 2, v1
  v_mul_u32_u24 v15, 896, v15
  v_add_u32 v14, v14, v15
  v_and_b32 v1, 3, v1
  v_lshl_add_u32 v14, v1, 4, v14
  v_add_u32 v14, s3, v14
  v_subrev_u32 v17, 1024, v14
  v_add_u32 v1, 128, v0
  v_mul_u32_u24 v14, 43691, v1
  v_lshrrev_b32 v14, 19, v14
  v_mul_u32_u24 v15, 12, v14
  v_sub_u32 v1, v1, v15
  v_mul_u32_u24 v14, 2688, v14
  v_lshrrev_b32 v15, 2, v1
  v_mul_u32_u24 v15, 896, v15
  v_add_u32 v14, v14, v15
  v_and_b32 v1, 3, v1
  v_lshl_add_u32 v14, v1, 4, v14
  v_add_u32 v14, s3, v14
  v_subrev_u32 v18, 2048, v14
  s_mul_i32 s7, s4, 43008
  s_mul_i32 s3, s11, 172032
  s_add_u32 s7, s7, s3
  s_mul_i32 s8, s4, 3072
  s_cmp_ge_u32 s74, 4
  s_mov_b32 s74, s4
  s_mov_b32 s14, s11
  s_movk_i32 s4, 128
  s_mov_b32 s9, 172032
  s_waitcnt lgkmcnt(0)
  s_cbranch_scc1 k_F
  s_mov_b32 s36, s16
  s_mov_b32 s37, s17
  s_mov_b32 s38, 1835008
  s_mov_b32 s39, 0x00020000
  s_add_u32 m0, s6, 0
  s_add_u32 s14, s14, 1
  buffer_load_dwordx4 v20, s[36:39], s5 offen offset:0 lds
  buffer_load_dwordx4 v21, s[36:39], s5 offen offset:1024 lds
  buffer_load_dwordx4 v22, s[36:39], s5 offen offset:2048 lds
  buffer_load_dwordx4 v23, s[36:39], s5 offen offset:3072 lds
  s_cmp_eq_u32 s14, 7
  s_cselect_b32 s3, -768, s4
  s_add_u32 s5, s5, s3
  s_mov_b32 s40, s18
  s_mov_b32 s41, s19
  s_mov_b32 s42, 1204224
  s_mov_b32 s43, 0x00020000
  s_add_u32 m0, s8, 0
  s_add_u32 s15, s15, 1
  buffer_load_dwordx4 v16, s[40:43], s7 offen offset:0 lds
  buffer_load_dwordx4 v17, s[40:43], s7 offen offset:1024 lds
  buffer_load_dwordx4 v18, s[40:43], s7 offen offset:2048 lds
  s_cmp_eq_u32 s15, 7
  s_cselect_b32 s3, -1032192, s9
  s_add_u32 s7, s7, s3
  s_setprio 3
  s_add_u32 m0, s6, 16384
  s_add_u32 s14, s14, 1
  buffer_load_dwordx4 v20, s[36:39], s5 offen offset:0 lds
  buffer_load_dwordx4 v21, s[36:39], s5 offen offset:1024 lds
  buffer_load_dwordx4 v22, s[36:39], s5 offen offset:2048 lds
  buffer_load_dwordx4 v23, s[36:39], s5 offen offset:3072 lds
  s_cmp_eq_u32 s14, 7
  s_cselect_b32 s3, -768, s4
  s_add_u32 s5, s5, s3
  s_add_u32 m0, s8, 12288
  s_add_u32 s15, s15, 1
  buffer_load_dwordx4 v16, s[40:43], s7 offen offset:0 lds
  buffer_load_dwordx4 v17, s[40:43], s7 offen offset:1024 lds
  buffer_load_dwordx4 v18, s[40:43], s7 offen offset:2048 lds
  s_cmp_eq_u32 s15, 7
  s_cselect_b32 s3, -1032192, s9
  s_add_u32 s7, s7, s3
  s_mov_b32 s44, s34
  s_mov_b32 s45, s35
  s_mov_b32 s46, 16908288
  s_mov_b32 s47, 0x00020000
  s_mov_b32 s68, s32
  s_mov_b32 s69, s33
  s_mov_b32 s70, 256
  s_mov_b32 s71, 0x00020000
  v_bfe_u32 v14, v0, 1, 3
  v_lshlrev_b32 v15, 7, v2
  v_add_u32 v1, 0, v3
  v_xor_b32 v1, v1, v14
  v_lshl_add_u32 v8, v1, 4, v15
  v_add_u32 v1, 2, v3
  v_xor_b32 v1, v1, v14
  v_lshl_add_u32 v9, v1, 4, v15
  v_add_u32 v1, 4, v3
  v_xor_b32 v1, v1, v14
  v_lshl_add_u32 v10, v1, 4, v15
  v_add_u32 v1, 6, v3
  v_xor_b32 v1, v1, v14
  v_lshl_add_u32 v11, v1, 4, v15
  s_lshl_b32 s3, s74, 12
  s_add_u32 s3, s3, 49152
  v_add_u32 v8, s3, v8
  v_add_u32 v9, s3, v9
  v_add_u32 v10, s3, v10
  v_add_u32 v11, s3, v11
  v_lshl_add_u32 v14, v3, 3, v4
  v_mul_u32_u24 v14, 192, v14
  v_lshl_add_u32 v14, v5, 5, v14
  v_lshl_add_u32 v12, v6, 3, v14
  s_and_b32 s3, s73, 1
  s_lshl_b32 s3, s3, 3
  v_add_u32 v12, s3, v12
  v_mov_b32 v31, 0x3f803f80
  v_cmp_eq_u32 vcc, 28, v2
  v_mov_b32 v24, 36908
  v_mov_b32 v25, 1
  v_cndmask_b32 v31, 0, v31, vcc
  v_mov_b32 v128, 0
  v_mov_b32 v129, 0
  v_mov_b32 v130, 0
  v_mov_b32 v131, 0
  s_nop 1
  v_mfma_f32_32x32x16_bf16 v[64:79], v[128:131], v[128:131], 0
  v_mfma_f32_32x32x16_bf16 v[80:95], v[128:131], v[128:131], 0
  v_mfma_f32_32x32x16_bf16 v[96:111], v[128:131], v[128:131], 0
  s_barrier
  s_waitcnt vmcnt(7) lgkmcnt(0)
  s_mov_b64 exec, 1
  ds_add_u32 v24, v25
  s_mov_b64 exec, -1
  s_add_u32 m0, s6, 32768
  s_add_u32 s14, s14, 1
  buffer_load_dwordx4 v20, s[36:39], s5 offen offset:0 lds
  buffer_load_dwordx4 v21, s[36:39], s5 offen offset:1024 lds
  buffer_load_dwordx4 v22, s[36:39], s5 offen offset:2048 lds
  buffer_load_dwordx4 v23, s[36:39], s5 offen offset:3072 lds
  s_cmp_eq_u32 s14, 7
  s_cselect_b32 s3, -768, s4
  s_add_u32 s5, s5, s3
  s_add_u32 m0, s8, 24576
  s_add_u32 s15, s15, 1
  buffer_load_dwordx4 v16, s[40:43], s7 offen offset:0 lds
  buffer_load_dwordx4 v17, s[40:43], s7 offen offset:1024 lds
  buffer_load_dwordx4 v18, s[40:43], s7 offen offset:2048 lds
  s_cmp_eq_u32 s15, 7
  s_cselect_b32 s3, -1032192, s9
  s_add_u32 s7, s7, s3
  s_mov_b32 s10, 0
sp_1:
  ds_read_b32 v26, v24
  s_add_u32 s10, s10, 1
  s_waitcnt lgkmcnt(0)
  v_readfirstlane_b32 s3, v26
  s_cmp_gt_u32 s10, 0x200000
  s_cbranch_scc1 spe_2
  s_cmp_ge_u32 s3, 4
  s_cbranch_scc0 sp_1
spe_2:
  ds_read_b128 v[32:35], v8 offset:0
  ds_read_b64_tr_b16 v[36:37], v12 offset:0
  ds_read_b64_tr_b16 v[38:39], v12 offset:768
  ds_read_b64_tr_b16 v[40:41], v12 offset:64
  ds_read_b64_tr_b16 v[42:43], v12 offset:832
  ds_read_b64_tr_b16 v[44:45], v12 offset:128
  ds_read_b64_tr_b16 v[46:47], v12 offset:896
  ds_read_b128 v[48:51], v9 offset:0
  ds_read_b64_tr_b16 v[52:53], v12 offset:3072
  ds_read_b64_tr_b16 v[54:55], v12 offset:3840
  ds_read_b64_tr_b16 v[56:57], v12 offset:3136
  ds_read_b64_tr_b16 v[58:59], v12 offset:3904
  ds_read_b64_tr_b16 v[60:61], v12 offset:3200
  ds_read_b64_tr_b16 v[62:63], v12 offset:3968
  s_add_u32 m0, s6, 49152
  s_add_u32 s14, s14, 1
  buffer_load_dwordx4 v20, s[36:39], s5 offen offset:0 lds
  buffer_load_dwordx4 v21, s[36:39], s5 offen offset:1024 lds
  buffer_load_dwordx4 v22, s[36:39], s5 offen offset:2048 lds
  buffer_load_dwordx4 v23, s[36:39], s5 offen offset:3072 lds
  s_cmp_eq_u32 s14, 7
  s_cselect_b32 s3, -768, s4
  s_add_u32 s5, s5, s3
  s_waitcnt lgkmcnt(7)
  v_mfma_f32_32x32x16_bf16 v[64:79], v[36:39], v[32:35], v[64:79]
  ds_read_b128 v[128:131], v10 offset:0
  ds_read_b64_tr_b16 v[132:133], v12 offset:6144
  ds_read_b64_tr_b16 v[134:135], v12 offset:6912
  v_mfma_f32_32x32x16_bf16 v[80:95], v[40:43], v[32:35], v[80:95]
  ds_read_b64_tr_b16 v[136:137], v12 offset:6208
  ds_read_b64_tr_b16 v[138:139], v12 offset:6976
  v_mfma_f32_32x32x16_bf16 v[96:111], v[32:35], v[44:47], v[96:111]
  ds_read_b64_tr_b16 v[140:141], v12 offset:6272
  ds_read_b64_tr_b16 v[142:143], v12 offset:7040
  s_waitcnt lgkmcnt(7)
  v_mfma_f32_32x32x16_bf16 v[64:79], v[52:55], v[48:51], v[64:79]
  ds_read_b128 v[144:147], v11 offset:0
  ds_read_b64_tr_b16 v[148:149], v12 offset:9216
  ds_read_b64_tr_b16 v[150:151], v12 offset:9984
  v_mfma_f32_32x32x16_bf16 v[80:95], v[56:59], v[48:51], v[80:95]
  ds_read_b64_tr_b16 v[152:153], v12 offset:9280
  ds_read_b64_tr_b16 v[154:155], v12 offset:10048
  v_mfma_f32_32x32x16_bf16 v[96:111], v[48:51], v[60:63], v[96:111]
  ds_read_b64_tr_b16 v[156:157], v12 offset:9344
  ds_read_b64_tr_b16 v[158:159], v12 offset:10112
  s_waitcnt vmcnt(11) lgkmcnt(0)
  s_mov_b64 exec, 1
  ds_add_u32 v24, v25
  s_mov_b64 exec, -1
  v_mfma_f32_32x32x16_bf16 v[64:79], v[132:135], v[128:131], v[64:79]
  v_mfma_f32_32x32x16_bf16 v[80:95], v[136:139], v[128:131], v[80:95]
  v_mfma_f32_32x32x16_bf16 v[96:111], v[128:131], v[140:143], v[96:111]
  s_mov_b32 s10, 0
sp_3:
  ds_read_b32 v26, v24
  s_add_u32 s10, s10, 1
  s_waitcnt lgkmcnt(0)
  v_readfirstlane_b32 s3, v26
  s_cmp_gt_u32 s10, 0x200000
  s_cbranch_scc1 spe_4
  s_cmp_ge_u32 s3, 8
  s_cbranch_scc0 sp_3
spe_4:
  v_mfma_f32_32x32x16_bf16 v[64:79], v[148:151], v[144:147], v[64:79]
  ds_read_b128 v[32:35], v8 offset:16384
  ds_read_b64_tr_b16 v[36:37], v12 offset:12288
  ds_read_b64_tr_b16 v[38:39], v12 offset:13056
  ds_read_b64_tr_b16 v[40:41], v12 offset:12352
  ds_read_b64_tr_b16 v[42:43], v12 offset:13120
  v_mfma_f32_32x32x16_bf16 v[80:95], v[152:155], v[144:147], v[80:95]
  ds_read_b64_tr_b16 v[44:45], v12 offset:12416
  ds_read_b64_tr_b16 v[46:47], v12 offset:13184
  ds_read_b128 v[48:51], v9 offset:16384
  ds_read_b64_tr_b16 v[52:53], v12 offset:15360
  ds_read_b64_tr_b16 v[54:55], v12 offset:16128
  v_mfma_f32_32x32x16_bf16 v[96:111], v[144:147], v[156:159], v[96:111]
  ds_read_b64_tr_b16 v[56:57], v12 offset:15424
  ds_read_b64_tr_b16 v[58:59], v12 offset:16192
  ds_read_b64_tr_b16 v[60:61], v12 offset:15488
  ds_read_b64_tr_b16 v[62:63], v12 offset:16256
  s_add_u32 m0, s8, 0
  s_add_u32 s15, s15, 1
  buffer_load_dwordx4 v16, s[40:43], s7 offen offset:0 lds
  buffer_load_dwordx4 v17, s[40:43], s7 offen offset:1024 lds
  buffer_load_dwordx4 v18, s[40:43], s7 offen offset:2048 lds
  s_cmp_eq_u32 s15, 7
  s_cselect_b32 s3, -1032192, s9
  s_add_u32 s7, s7, s3
  s_add_u32 m0, s6, 65536
  s_add_u32 s14, s14, 1
  buffer_load_dwordx4 v20, s[36:39], s5 offen offset:0 lds
  buffer_load_dwordx4 v21, s[36:39], s5 offen offset:1024 lds
  buffer_load_dwordx4 v22, s[36:39], s5 offen offset:2048 lds
  buffer_load_dwordx4 v23, s[36:39], s5 offen offset:3072 lds
  s_cmp_eq_u32 s14, 7
  s_cselect_b32 s3, -768, s4
  s_add_u32 s5, s5, s3
  s_waitcnt lgkmcnt(7)
  v_mfma_f32_32x32x16_bf16 v[64:79], v[36:39], v[32:35], v[64:79]
  ds_read_b128 v[128:131], v10 offset:16384
  ds_read_b64_tr_b16 v[132:133], v12 offset:18432
  ds_read_b64_tr_b16 v[134:135], v12 offset:19200
  v_mfma_f32_32x32x16_bf16 v[80:95], v[40:43], v[32:35], v[80:95]
  ds_read_b64_tr_b16 v[136:137], v12 offset:18496
  ds_read_b64_tr_b16 v[138:139], v12 offset:19264
  v_mfma_f32_32x32x16_bf16 v[96:111], v[32:35], v[44:47], v[96:111]
  ds_read_b64_tr_b16 v[140:141], v12 offset:18560
  ds_read_b64_tr_b16 v[142:143], v12 offset:19328
  s_waitcnt lgkmcnt(7)
  v_mfma_f32_32x32x16_bf16 v[64:79], v[52:55], v[48:51], v[64:79]
  ds_read_b128 v[144:147], v11 offset:16384
  ds_read_b64_tr_b16 v[148:149], v12 offset:21504
  ds_read_b64_tr_b16 v[150:151], v12 offset:22272
  v_mfma_f32_32x32x16_bf16 v[80:95], v[56:59], v[48:51], v[80:95]
  ds_read_b64_tr_b16 v[152:153], v12 offset:21568
  ds_read_b64_tr_b16 v[154:155], v12 offset:22336
  v_mfma_f32_32x32x16_bf16 v[96:111], v[48:51], v[60:63], v[96:111]
  ds_read_b64_tr_b16 v[156:157], v12 offset:21632
  ds_read_b64_tr_b16 v[158:159], v12 offset:22400
  s_waitcnt vmcnt(11) lgkmcnt(0)
  s_mov_b64 exec, 1
  ds_add_u32 v24, v25
  s_mov_b64 exec, -1
  v_mfma_f32_32x32x16_bf16 v[64:79], v[132:135], v[128:131], v[64:79]
  v_mfma_f32_32x32x16_bf16 v[80:95], v[136:139], v[128:131], v[80:95]
  v_mfma_f32_32x32x16_bf16 v[96:111], v[128:131], v[140:143], v[96:111]
  s_mov_b32 s10, 0
sp_5:
  ds_read_b32 v26, v24
  s_add_u32 s10, s10, 1
  s_waitcnt lgkmcnt(0)
  v_readfirstlane_b32 s3, v26
  s_cmp_gt_u32 s10, 0x200000
  s_cbranch_scc1 spe_6
  s_cmp_ge_u32 s3, 12
  s_cbranch_scc0 sp_5
spe_6:
  v_mfma_f32_32x32x16_bf16 v[64:79], v[148:151], v[144:147], v[64:79]
  ds_read_b128 v[32:35], v8 offset:32768
  ds_read_b64_tr_b16 v[36:37], v12 offset:24576
  ds_read_b64_tr_b16 v[38:39], v12 offset:25344
  ds_read_b64_tr_b16 v[40:41], v12 offset:24640
  ds_read_b64_tr_b16 v[42:43], v12 offset:25408
  v_mfma_f32_32x32x16_bf16 v[80:95], v[152:155], v[144:147], v[80:95]
  ds_read_b64_tr_b16 v[44:45], v12 offset:24704
  ds_read_b64_tr_b16 v[46:47], v12 offset:25472
  ds_read_b128 v[48:51], v9 offset:32768
  ds_read_b64_tr_b16 v[52:53], v12 offset:27648
  ds_read_b64_tr_b16 v[54:55], v12 offset:28416
  v_mfma_f32_32x32x16_bf16 v[96:111], v[144:147], v[156:159], v[96:111]
  ds_read_b64_tr_b16 v[56:57], v12 offset:27712
  ds_read_b64_tr_b16 v[58:59], v12 offset:28480
  ds_read_b64_tr_b16 v[60:61], v12 offset:27776
  ds_read_b64_tr_b16 v[62:63], v12 offset:28544
  s_add_u32 m0, s8, 12288
  s_add_u32 s15, s15, 1
  buffer_load_dwordx4 v16, s[40:43], s7 offen offset:0 lds
  buffer_load_dwordx4 v17, s[40:43], s7 offen offset:1024 lds
  buffer_load_dwordx4 v18, s[40:43], s7 offen offset:2048 lds
  s_cmp_eq_u32 s15, 7
  s_cselect_b32 s3, -1032192, s9
  s_add_u32 s7, s7, s3
  s_add_u32 m0, s6, 81920
  s_add_u32 s14, s14, 1
  buffer_load_dwordx4 v20, s[36:39], s5 offen offset:0 lds
  buffer_load_dwordx4 v21, s[36:39], s5 offen offset:1024 lds
  buffer_load_dwordx4 v22, s[36:39], s5 offen offset:2048 lds
  buffer_load_dwordx4 v23, s[36:39], s5 offen offset:3072 lds
  s_cmp_eq_u32 s14, 7
  s_cselect_b32 s3, -768, s4
  s_add_u32 s5, s5, s3
  s_waitcnt lgkmcnt(7)
  v_mfma_f32_32x32x16_bf16 v[64:79], v[36:39], v[32:35], v[64:79]
  ds_read_b128 v[128:131], v10 offset:32768
  ds_read_b64_tr_b16 v[132:133], v12 offset:30720
  ds_read_b64_tr_b16 v[134:135], v12 offset:31488
  v_mfma_f32_32x32x16_bf16 v[80:95], v[40:43], v[32:35], v[80:95]
  ds_read_b64_tr_b16 v[136:137], v12 offset:30784
  ds_read_b64_tr_b16 v[138:139], v12 offset:31552
  v_mfma_f32_32x32x16_bf16 v[96:111], v[32:35], v[44:47], v[96:111]
  ds_read_b64_tr_b16 v[140:141], v12 offset:30848
  ds_read_b64_tr_b16 v[142:143], v12 offset:31616
  s_waitcnt lgkmcnt(7)
  v_mfma_f32_32x32x16_bf16 v[64:79], v[52:55], v[48:51], v[64:79]
  ds_read_b128 v[144:147], v11 offset:32768
  ds_read_b64_tr_b16 v[148:149], v12 offset:33792
  ds_read_b64_tr_b16 v[150:151], v12 offset:34560
  v_mfma_f32_32x32x16_bf16 v[80:95], v[56:59], v[48:51], v[80:95]
  ds_read_b64_tr_b16 v[152:153], v12 offset:33856
  ds_read_b64_tr_b16 v[154:155], v12 offset:34624
  v_mfma_f32_32x32x16_bf16 v[96:111], v[48:51], v[60:63], v[96:111]
  ds_read_b64_tr_b16 v[156:157], v12 offset:33920
  ds_read_b64_tr_b16 v[158:159], v12 offset:34688
  s_waitcnt vmcnt(11) lgkmcnt(0)
  s_mov_b64 exec, 1
  ds_add_u32 v24, v25
  s_mov_b64 exec, -1
  v_mfma_f32_32x32x16_bf16 v[64:79], v[132:135], v[128:131], v[64:79]
  v_mfma_f32_32x32x16_bf16 v[80:95], v[136:139], v[128:131], v[80:95]
  v_mfma_f32_32x32x16_bf16 v[96:111], v[128:131], v[140:143], v[96:111]
  s_mov_b32 s10, 0
sp_7:
  ds_read_b32 v26, v24
  s_add_u32 s10, s10, 1
  s_waitcnt lgkmcnt(0)
  v_readfirstlane_b32 s3, v26
  s_cmp_gt_u32 s10, 0x200000
  s_cbranch_scc1 spe_8
  s_cmp_ge_u32 s3, 16
  s_cbranch_scc0 sp_7
spe_8:
  v_mfma_f32_32x32x16_bf16 v[64:79], v[148:151], v[144:147], v[64:79]
  ds_read_b128 v[32:35], v8 offset:49152
  ds_read_b64_tr_b16 v[36:37], v12 offset:0
  ds_read_b64_tr_b16 v[38:39], v12 offset:768
  ds_read_b64_tr_b16 v[40:41], v12 offset:64
  ds_read_b64_tr_b16 v[42:43], v12 offset:832
  v_mfma_f32_32x32x16_bf16 v[80:95], v[152:155], v[144:147], v[80:95]
  ds_read_b64_tr_b16 v[44:45], v12 offset:128
  ds_read_b64_tr_b16 v[46:47], v12 offset:896
  ds_read_b128 v[48:51], v9 offset:49152
  ds_read_b64_tr_b16 v[52:53], v12 offset:3072
  ds_read_b64_tr_b16 v[54:55], v12 offset:3840
  v_mfma_f32_32x32x16_bf16 v[96:111], v[144:147], v[156:159], v[96:111]
  ds_read_b64_tr_b16 v[56:57], v12 offset:3136
  ds_read_b64_tr_b16 v[58:59], v12 offset:3904
  ds_read_b64_tr_b16 v[60:61], v12 offset:3200
  ds_read_b64_tr_b16 v[62:63], v12 offset:3968
  s_add_u32 m0, s8, 24576
  s_add_u32 s15, s15, 1
  buffer_load_dwordx4 v16, s[40:43], s7 offen offset:0 lds
  buffer_load_dwordx4 v17, s[40:43], s7 offen offset:1024 lds
  buffer_load_dwordx4 v18, s[40:43], s7 offen offset:2048 lds
  s_cmp_eq_u32 s15, 7
  s_cselect_b32 s3, -1032192, s9
  s_add_u32 s7, s7, s3
  s_add_u32 m0, s6, 98304
  s_add_u32 s14, s14, 1
  buffer_load_dwordx4 v20, s[36:39], s5 offen offset:0 lds
  buffer_load_dwordx4 v21, s[36:39], s5 offen offset:1024 lds
  buffer_load_dwordx4 v22, s[36:39], s5 offen offset:2048 lds
  buffer_load_dwordx4 v23, s[36:39], s5 offen offset:3072 lds
  s_cmp_eq_u32 s14, 7
  s_cselect_b32 s3, -768, s4
  s_add_u32 s5, s5, s3
  s_waitcnt lgkmcnt(7)
  v_mfma_f32_32x32x16_bf16 v[64:79], v[36:39], v[32:35], v[64:79]
  ds_read_b128 v[128:131], v10 offset:49152
  ds_read_b64_tr_b16 v[132:133], v12 offset:6144
  ds_read_b64_tr_b16 v[134:135], v12 offset:6912
  v_mfma_f32_32x32x16_bf16 v[80:95], v[40:43], v[32:35], v[80:95]
  ds_read_b64_tr_b16 v[136:137], v12 offset:6208
  ds_read_b64_tr_b16 v[138:139], v12 offset:6976
  v_mfma_f32_32x32x16_bf16 v[96:111], v[32:35], v[44:47], v[96:111]
  ds_read_b64_tr_b16 v[140:141], v12 offset:6272
  ds_read_b64_tr_b16 v[142:143], v12 offset:7040
  s_waitcnt lgkmcnt(7)
  v_mfma_f32_32x32x16_bf16 v[64:79], v[52:55], v[48:51], v[64:79]
  ds_read_b128 v[144:147], v11 offset:49152
  ds_read_b64_tr_b16 v[148:149], v12 offset:9216
  ds_read_b64_tr_b16 v[150:151], v12 offset:9984
  v_mfma_f32_32x32x16_bf16 v[80:95], v[56:59], v[48:51], v[80:95]
  ds_read_b64_tr_b16 v[152:153], v12 offset:9280
  ds_read_b64_tr_b16 v[154:155], v12 offset:10048
  v_mfma_f32_32x32x16_bf16 v[96:111], v[48:51], v[60:63], v[96:111]
  ds_read_b64_tr_b16 v[156:157], v12 offset:9344
  ds_read_b64_tr_b16 v[158:159], v12 offset:10112
  s_waitcnt vmcnt(11) lgkmcnt(0)
  s_mov_b64 exec, 1
  ds_add_u32 v24, v25
  s_mov_b64 exec, -1
  v_mfma_f32_32x32x16_bf16 v[64:79], v[132:135], v[128:131], v[64:79]
  v_mfma_f32_32x32x16_bf16 v[80:95], v[136:139], v[128:131], v[80:95]
  v_mfma_f32_32x32x16_bf16 v[96:111], v[128:131], v[140:143], v[96:111]
  s_mov_b32 s10, 0
sp_9:
  ds_read_b32 v26, v24
  s_add_u32 s10, s10, 1
  s_waitcnt lgkmcnt(0)
  v_readfirstlane_b32 s3, v26
  s_cmp_gt_u32 s10, 0x200000
  s_cbranch_scc1 spe_10
  s_cmp_ge_u32 s3, 20
  s_cbranch_scc0 sp_9
spe_10:
  v_add_u32 v8, 0x10000, v8
  v_add_u32 v9, 0x10000, v9
  v_add_u32 v10, 0x10000, v10
  v_add_u32 v11, 0x10000, v11
  v_mfma_f32_32x32x16_bf16 v[64:79], v[148:151], v[144:147], v[64:79]
  ds_read_b128 v[32:35], v8 offset:0
  ds_read_b64_tr_b16 v[36:37], v12 offset:12288
  ds_read_b64_tr_b16 v[38:39], v12 offset:13056
  ds_read_b64_tr_b16 v[40:41], v12 offset:12352
  ds_read_b64_tr_b16 v[42:43], v12 offset:13120
  v_mfma_f32_32x32x16_bf16 v[80:95], v[152:155], v[144:147], v[80:95]
  ds_read_b64_tr_b16 v[44:45], v12 offset:12416
  ds_read_b64_tr_b16 v[46:47], v12 offset:13184
  ds_read_b128 v[48:51], v9 offset:0
  ds_read_b64_tr_b16 v[52:53], v12 offset:15360
  ds_read_b64_tr_b16 v[54:55], v12 offset:16128
  v_mfma_f32_32x32x16_bf16 v[96:111], v[144:147], v[156:159], v[96:111]
  ds_read_b64_tr_b16 v[56:57], v12 offset:15424
  ds_read_b64_tr_b16 v[58:59], v12 offset:16192
  ds_read_b64_tr_b16 v[60:61], v12 offset:15488
  ds_read_b64_tr_b16 v[62:63], v12 offset:16256
  s_add_u32 m0, s8, 0
  s_add_u32 s15, s15, 1
  buffer_load_dwordx4 v16, s[40:43], s7 offen offset:0 lds
  buffer_load_dwordx4 v17, s[40:43], s7 offen offset:1024 lds
  buffer_load_dwordx4 v18, s[40:43], s7 offen offset:2048 lds
  s_cmp_eq_u32 s15, 7
  s_cselect_b32 s3, -1032192, s9
  s_add_u32 s7, s7, s3
  v_mov_b32 v16, 0
  buffer_load_dwordx2 v[18:19], v16, s[68:71], 0 offen sc1
  s_waitcnt lgkmcnt(7)
  v_mfma_f32_32x32x16_bf16 v[64:79], v[36:39], v[32:35], v[64:79]
  ds_read_b128 v[128:131], v10 offset:0
  ds_read_b64_tr_b16 v[132:133], v12 offset:18432
  ds_read_b64_tr_b16 v[134:135], v12 offset:19200
  v_mfma_f32_32x32x16_bf16 v[80:95], v[40:43], v[32:35], v[80:95]
  ds_read_b64_tr_b16 v[136:137], v12 offset:18496
  ds_read_b64_tr_b16 v[138:139], v12 offset:19264
  v_mfma_f32_32x32x16_bf16 v[96:111], v[32:35], v[44:47], v[96:111]
  ds_read_b64_tr_b16 v[140:141], v12 offset:18560
  ds_read_b64_tr_b16 v[142:143], v12 offset:19328
  s_waitcnt lgkmcnt(7)
  v_mfma_f32_32x32x16_bf16 v[64:79], v[52:55], v[48:51], v[64:79]
  ds_read_b128 v[144:147], v11 offset:0
  ds_read_b64_tr_b16 v[148:149], v12 offset:21504
  ds_read_b64_tr_b16 v[150:151], v12 offset:22272
  v_mfma_f32_32x32x16_bf16 v[80:95], v[56:59], v[48:51], v[80:95]
  ds_read_b64_tr_b16 v[152:153], v12 offset:21568
  ds_read_b64_tr_b16 v[154:155], v12 offset:22336
  v_mfma_f32_32x32x16_bf16 v[96:111], v[48:51], v[60:63], v[96:111]
  ds_read_b64_tr_b16 v[156:157], v12 offset:21632
  ds_read_b64_tr_b16 v[158:159], v12 offset:22400
  s_waitcnt vmcnt(8) lgkmcnt(0)
  s_mov_b64 exec, 1
  ds_add_u32 v24, v25
  s_mov_b64 exec, -1
  v_mfma_f32_32x32x16_bf16 v[64:79], v[132:135], v[128:131], v[64:79]
  v_mfma_f32_32x32x16_bf16 v[80:95], v[136:139], v[128:131], v[80:95]
  v_mfma_f32_32x32x16_bf16 v[96:111], v[128:131], v[140:143], v[96:111]
  s_mov_b32 s10, 0
sp_11:
  ds_read_b32 v26, v24
  s_add_u32 s10, s10, 1
  s_waitcnt lgkmcnt(0)
  v_readfirstlane_b32 s3, v26
  s_cmp_gt_u32 s10, 0x200000
  s_cbranch_scc1 spe_12
  s_cmp_ge_u32 s3, 24
  s_cbranch_scc0 sp_11
spe_12:
  v_mfma_f32_32x32x16_bf16 v[64:79], v[148:151], v[144:147], v[64:79]
  ds_read_b128 v[32:35], v8 offset:16384
  ds_read_b64_tr_b16 v[36:37], v12 offset:24576
  ds_read_b64_tr_b16 v[38:39], v12 offset:25344
  ds_read_b64_tr_b16 v[40:41], v12 offset:24640
  ds_read_b64_tr_b16 v[42:43], v12 offset:25408
  v_mfma_f32_32x32x16_bf16 v[80:95], v[152:155], v[144:147], v[80:95]
  ds_read_b64_tr_b16 v[44:45], v12 offset:24704
  ds_read_b64_tr_b16 v[46:47], v12 offset:25472
  ds_read_b128 v[48:51], v9 offset:16384
  ds_read_b64_tr_b16 v[52:53], v12 offset:27648
  ds_read_b64_tr_b16 v[54:55], v12 offset:28416
  v_mfma_f32_32x32x16_bf16 v[96:111], v[144:147], v[156:159], v[96:111]
  ds_read_b64_tr_b16 v[56:57], v12 offset:27712
  ds_read_b64_tr_b16 v[58:59], v12 offset:28480
  ds_read_b64_tr_b16 v[60:61], v12 offset:27776
  ds_read_b64_tr_b16 v[62:63], v12 offset:28544
  s_waitcnt lgkmcnt(7)
  v_mfma_f32_32x32x16_bf16 v[64:79], v[36:39], v[32:35], v[64:79]
  ds_read_b128 v[128:131], v10 offset:16384
  ds_read_b64_tr_b16 v[132:133], v12 offset:30720
  ds_read_b64_tr_b16 v[134:135], v12 offset:31488
  v_mfma_f32_32x32x16_bf16 v[80:95], v[40:43], v[32:35], v[80:95]
  ds_read_b64_tr_b16 v[136:137], v12 offset:30784
  ds_read_b64_tr_b16 v[138:139], v12 offset:31552
  v_mfma_f32_32x32x16_bf16 v[96:111], v[32:35], v[44:47], v[96:111]
  ds_read_b64_tr_b16 v[140:141], v12 offset:30848
  ds_read_b64_tr_b16 v[142:143], v12 offset:31616
  s_waitcnt lgkmcnt(7)
  v_mfma_f32_32x32x16_bf16 v[64:79], v[52:55], v[48:51], v[64:79]
  ds_read_b128 v[144:147], v11 offset:16384
  ds_read_b64_tr_b16 v[148:149], v12 offset:33792
  ds_read_b64_tr_b16 v[150:151], v12 offset:34560
  v_mfma_f32_32x32x16_bf16 v[80:95], v[56:59], v[48:51], v[80:95]
  ds_read_b64_tr_b16 v[152:153], v12 offset:33856
  ds_read_b64_tr_b16 v[154:155], v12 offset:34624
  v_mfma_f32_32x32x16_bf16 v[96:111], v[48:51], v[60:63], v[96:111]
  ds_read_b64_tr_b16 v[156:157], v12 offset:33920
  ds_read_b64_tr_b16 v[158:159], v12 offset:34688
  s_waitcnt vmcnt(1) lgkmcnt(0)
  s_mov_b64 exec, 1
  ds_add_u32 v24, v25
  s_mov_b64 exec, -1
  v_mfma_f32_32x32x16_bf16 v[64:79], v[132:135], v[128:131], v[64:79]
  v_mfma_f32_32x32x16_bf16 v[80:95], v[136:139], v[128:131], v[80:95]
  v_mfma_f32_32x32x16_bf16 v[96:111], v[128:131], v[140:143], v[96:111]
  s_mov_b32 s10, 0
sp_13:
  ds_read_b32 v26, v24
  s_add_u32 s10, s10, 1
  s_waitcnt lgkmcnt(0)
  v_readfirstlane_b32 s3, v26
  s_cmp_gt_u32 s10, 0x200000
  s_cbranch_scc1 spe_14
  s_cmp_ge_u32 s3, 28
  s_cbranch_scc0 sp_13
spe_14:
  v_mfma_f32_32x32x16_bf16 v[64:79], v[148:151], v[144:147], v[64:79]
  ds_read_b128 v[32:35], v8 offset:32768
  ds_read_b64_tr_b16 v[36:37], v12 offset:0
  ds_read_b64_tr_b16 v[38:39], v12 offset:768
  ds_read_b64_tr_b16 v[40:41], v12 offset:64
  ds_read_b64_tr_b16 v[42:43], v12 offset:832
  v_mfma_f32_32x32x16_bf16 v[80:95], v[152:155], v[144:147], v[80:95]
  ds_read_b64_tr_b16 v[44:45], v12 offset:128
  ds_read_b64_tr_b16 v[46:47], v12 offset:896
  ds_read_b128 v[48:51], v9 offset:32768
  ds_read_b64_tr_b16 v[52:53], v12 offset:3072
  ds_read_b64_tr_b16 v[54:55], v12 offset:3840
  v_mfma_f32_32x32x16_bf16 v[96:111], v[144:147], v[156:159], v[96:111]
  ds_read_b64_tr_b16 v[56:57], v12 offset:3136
  ds_read_b64_tr_b16 v[58:59], v12 offset:3904
  ds_read_b64_tr_b16 v[60:61], v12 offset:3200
  ds_read_b64_tr_b16 v[62:63], v12 offset:3968
  s_waitcnt lgkmcnt(7)
  v_mfma_f32_32x32x16_bf16 v[64:79], v[36:39], v[32:35], v[64:79]
  ds_read_b128 v[128:131], v10 offset:32768
  ds_read_b64_tr_b16 v[132:133], v12 offset:6144
  ds_read_b64_tr_b16 v[134:135], v12 offset:6912
  v_mfma_f32_32x32x16_bf16 v[80:95], v[40:43], v[32:35], v[80:95]
  ds_read_b64_tr_b16 v[136:137], v12 offset:6208
  ds_read_b64_tr_b16 v[138:139], v12 offset:6976
  v_mfma_f32_32x32x16_bf16 v[96:111], v[32:35], v[44:47], v[96:111]
  ds_read_b64_tr_b16 v[140:141], v12 offset:6272
  ds_read_b64_tr_b16 v[142:143], v12 offset:7040
  s_waitcnt lgkmcnt(7)
  v_mfma_f32_32x32x16_bf16 v[64:79], v[52:55], v[48:51], v[64:79]
  ds_read_b128 v[144:147], v11 offset:32768
  ds_read_b64_tr_b16 v[148:149], v12 offset:9216
  ds_read_b64_tr_b16 v[150:151], v12 offset:9984
  v_mfma_f32_32x32x16_bf16 v[80:95], v[56:59], v[48:51], v[80:95]
  ds_read_b64_tr_b16 v[152:153], v12 offset:9280
  ds_read_b64_tr_b16 v[154:155], v12 offset:10048
  v_mfma_f32_32x32x16_bf16 v[96:111], v[48:51], v[60:63], v[96:111]
  ds_read_b64_tr_b16 v[156:157], v12 offset:9344
  ds_read_b64_tr_b16 v[158:159], v12 offset:10112
  s_waitcnt lgkmcnt(0)
  v_mov_b32 v14, 36892
  v_mov_b32 v15, 1
  s_mov_b64 exec, 1
  ds_add_u32 v14, v15
  s_mov_b64 exec, -1
  v_mfma_f32_32x32x16_bf16 v[64:79], v[132:135], v[128:131], v[64:79]
  v_mfma_f32_32x32x16_bf16 v[80:95], v[136:139], v[128:131], v[80:95]
  v_mfma_f32_32x32x16_bf16 v[96:111], v[128:131], v[140:143], v[96:111]
  v_mfma_f32_32x32x16_bf16 v[64:79], v[148:151], v[144:147], v[64:79]
  v_mfma_f32_32x32x16_bf16 v[80:95], v[152:155], v[144:147], v[80:95]
  v_mfma_f32_32x32x16_bf16 v[96:111], v[144:147], v[156:159], v[96:111]
  s_lshl_b32 s3, s73, 6
  s_lshl_b32 s4, s72, 2
  s_add_u32 s3, s3, s4
  s_add_u32 s3, s3, s74
  s_lshl_b32 s6, s3, 12
  s_add_u32 s6, s6, 2097152
  s_lshl_b32 s7, s3, 3
  s_add_u32 s7, s7, 16842752
  s_mov_b32 s8, 0x3e8b97f6
  s_mov_b32 s9, 0x3e8b97f6
  s_mov_b32 s10, 0x07060302
  v_cvt_pk_bf16_f32 v40, v80, v81
  v_cvt_pk_bf16_f32 v41, v82, v83
  v_cvt_pk_bf16_f32 v42, v84, v85
  v_cvt_pk_bf16_f32 v43, v86, v87
  v_cvt_pk_bf16_f32 v44, v88, v89
  v_cvt_pk_bf16_f32 v45, v90, v91
  v_cvt_pk_bf16_f32 v46, v92, v93
  v_cvt_pk_bf16_f32 v47, v94, v95
  s_mov_b32 exec_lo, 0
  v_mov_b32 v46, 0x3f803f80
  v_mov_b32 v47, 0x3f80
  s_mov_b64 exec, -1
  buffer_store_dwordx4 v[40:43], v7, s[44:47], s6 offen sc1
  buffer_store_dwordx4 v[44:47], v7, s[44:47], s6 offen offset:1024 sc1
  v_cvt_pk_bf16_f32 v48, v96, v97
  v_cvt_pk_bf16_f32 v49, v98, v99
  v_cvt_pk_bf16_f32 v50, v100, v101
  v_cvt_pk_bf16_f32 v51, v102, v103
  v_cvt_pk_bf16_f32 v52, v104, v105
  v_cvt_pk_bf16_f32 v53, v106, v107
  v_cvt_pk_bf16_f32 v54, v108, v109
  v_cvt_pk_bf16_f32 v55, v110, v111
  s_mov_b32 exec_lo, 0xf0000000
  s_mov_b32 exec_hi, 0xf0000000
  v_mov_b32 v48, v31
  v_mov_b32 v49, v31
  v_mov_b32 v50, v31
  v_mov_b32 v51, v31
  v_mov_b32 v52, v31
  v_mov_b32 v53, v31
  v_mov_b32 v54, v31
  v_mov_b32 v55, v31
  s_mov_b64 exec, -1
  buffer_store_dwordx4 v[48:51], v7, s[44:47], s6 offen offset:2048 sc1
  buffer_store_dwordx4 v[52:55], v7, s[44:47], s6 offen offset:3072 sc1
  v_mul_f32 v64, s8, v64
  v_mul_f32 v65, s8, v65
  v_mul_f32 v66, s8, v66
  v_mul_f32 v67, s8, v67
  v_mul_f32 v68, s8, v68
  v_mul_f32 v69, s8, v69
  v_mul_f32 v70, s8, v70
  v_mul_f32 v71, s8, v71
  v_mul_f32 v72, s8, v72
  v_mul_f32 v73, s8, v73
  v_mul_f32 v74, s8, v74
  v_mul_f32 v75, s8, v75
  v_mul_f32 v76, s8, v76
  v_mul_f32 v77, s8, v77
  v_mul_f32 v78, s8, v78
  v_mul_f32 v79, s8, v79
  v_cvt_pk_bf16_f32 v32, v64, v65
  v_cvt_pk_bf16_f32 v33, v66, v67
  v_cvt_pk_bf16_f32 v34, v68, v69
  v_cvt_pk_bf16_f32 v35, v70, v71
  v_cvt_pk_bf16_f32 v36, v72, v73
  v_cvt_pk_bf16_f32 v37, v74, v75
  v_cvt_pk_bf16_f32 v38, v76, v77
  v_cvt_pk_bf16_f32 v39, v78, v79
  s_mov_b32 exec_lo, 0
  v_mov_b32 v38, 0
  v_mov_b32 v39, 0
  s_mov_b64 exec, -1
  s_lshl_b32 s3, s74, 11
  s_add_u32 s3, s3, 12288
  v_add_u32 v13, s3, v7
  v_mfma_f32_32x32x16_bf16 v[112:127], v[40:43], v[32:35], 0
  v_mfma_f32_32x32x16_bf16 v[112:127], v[44:47], v[36:39], v[112:127]
  s_nop 12
  v_max3_f32 v14, v112, v113, v114
  v_max3_f32 v15, v115, v116, v117
  v_max3_f32 v14, v14, v118, v119
  v_max3_f32 v15, v15, v120, v121
  v_max3_f32 v14, v14, v122, v123
  v_max3_f32 v15, v15, v124, v125
  v_max3_f32 v14, v14, v126, v127
  v_max_f32 v14, v14, v15
  v_mov_b32 v15, v14
  s_nop 1
  v_permlane32_swap_b32 v14, v15
  v_max_f32 v14, v14, v15
  v_sub_f32 v14, 0, v14
  v_and_b32 v15, 0xffff0000, v14
  v_sub_f32 v15, v14, v15
  v_and_b32 v12, 0xffff0000, v15
  v_sub_f32 v12, v15, v12
  s_mov_b32 exec_lo, 0
  v_perm_b32 v38, v15, v14, s10
  v_lshrrev_b32 v39, 16, v12
  s_mov_b64 exec, -1
  s_mov_b32 s14, 0
ng_15:
  s_waitcnt vmcnt(0)
  v_readfirstlane_b32 s12, v18
  v_readfirstlane_b32 s13, v19
  s_add_u32 s14, s14, 1
  s_cmp_gt_u32 s14, 0x40000
  s_cbranch_scc1 nge_16
  s_cmp_lg_u32 s12, 0
  s_cbranch_scc1 nge_16
  buffer_load_dwordx2 v[18:19], v16, s[68:71], 0 offen sc1
  s_branch ng_15
nge_16:
  v_mov_b32 v16, s12
  v_mov_b32 v17, s13
  v_mov_b32 v18, 0
  s_mov_b64 exec, 1
  buffer_store_dwordx2 v[16:17], v18, s[44:47], s7 offen sc1
  s_mov_b64 exec, -1
  ds_write_b128 v13, v[32:35]
  ds_write_b128 v13, v[36:39] offset:1024
  v_mov_b32 v14, 36904
  v_mov_b32 v15, 1
  s_mov_b64 exec, 1
  ds_add_u32 v14, v15
  s_mov_b64 exec, -1
  s_lshl_b32 s3, s73, 6
  s_lshl_b32 s11, s74, 4
  s_add_u32 s3, s3, s11
  s_lshl_b32 s3, s3, 12
  s_add_u32 s3, s3, 2097152
  s_add_u32 s48, s34, s3
  s_addc_u32 s49, s35, 0
  s_mov_b32 s50, 65536
  s_mov_b32 s51, 0x00020000
  s_mov_b32 s9, 0
  s_mov_b32 s10, 0
  s_lshl_b32 s11, s73, 9
  s_lshl_b32 s3, s72, 9
  s_sub_u32 s3, s3, s11
  s_add_u32 s3, s3, 8128
  v_lshlrev_b32 v248, 4, v0
  v_add_u32 v249, s3, v248
  v_cmp_gt_u32 vcc, 32, v0
  s_add_u32 s7, s11, 16842752
  s_nop 0
  v_cndmask_b32 v248, v249, v248, vcc
  v_mov_b32 v144, 0
  v_mov_b32 v145, 0
  v_mov_b32 v146, 0
  v_mov_b32 v147, 0
  s_nop 1
  v_mfma_f32_32x32x16_bf16 v[40:55], v[144:147], v[144:147], 0
  v_mfma_f32_32x32x16_bf16 v[56:71], v[144:147], v[144:147], 0
  v_mfma_f32_32x32x16_bf16 v[72:87], v[144:147], v[144:147], 0
  v_mfma_f32_32x32x16_bf16 v[88:103], v[144:147], v[144:147], 0
  v_mov_b32 v250, 36904
  s_mov_b32 s14, 0
lw_17:
  ds_read_b32 v251, v250
  s_add_u32 s14, s14, 1
  s_waitcnt lgkmcnt(0)
  v_readfirstlane_b32 s15, v251
  s_cmp_gt_u32 s14, 0x200000
  s_cbranch_scc1 lwe_18
  s_cmp_ge_u32 s15, 4
  s_cbranch_scc1 lwe_18
  s_branch lw_17
lwe_18:
  s_add_u32 s3, s74, 1
  s_and_b32 s3, s3, 3
  s_lshl_b32 s3, s3, 11
  v_add_u32 v1, s3, v7
  ds_read_b128 v[8:11], v1 offset:12288
  ds_read_b128 v[12:15], v1 offset:13312
  s_add_u32 s3, s74, 2
  s_and_b32 s3, s3, 3
  s_lshl_b32 s3, s3, 11
  v_add_u32 v1, s3, v7
  ds_read_b128 v[16:19], v1 offset:12288
  ds_read_b128 v[20:23], v1 offset:13312
  s_add_u32 s3, s74, 3
  s_and_b32 s3, s3, 3
  s_lshl_b32 s3, s3, 11
  v_add_u32 v1, s3, v7
  ds_read_b128 v[24:27], v1 offset:12288
  ds_read_b128 v[28:31], v1 offset:13312
  s_add_u32 s3, s74, 4
  s_and_b32 s3, s3, 3
  s_lshl_b32 s3, s3, 11
  v_add_u32 v1, s3, v7
  ds_read_b128 v[32:35], v1 offset:12288
  ds_read_b128 v[36:39], v1 offset:13312
  s_cmp_lg_u32 s74, 0
  s_cbranch_scc1 k_a_w
  s_mov_b32 exec_lo, 0xffffffff
  s_mov_b32 exec_hi, 0x3
  s_mov_b32 s14, 0
pl_19:
  buffer_load_dwordx4 v[252:255], v248, s[44:47], s7 offen sc1
  s_add_u32 s14, s14, 1
  s_waitcnt vmcnt(0)
  v_cmp_eq_u64 vcc, s[12:13], v[252:253]
  v_cmp_eq_u64 s[78:79], s[12:13], v[254:255]
  s_cmp_gt_u32 s14, 0x40000
  s_cbranch_scc1 ple_20
  s_and_b64 vcc, vcc, s[78:79]
  s_cmp_eq_u64 vcc, exec
  s_cbranch_scc1 ple_20
  s_sleep 3
  s_branch pl_19
ple_20:
  s_mov_b64 exec, -1
  v_mov_b32 v250, 36896
  v_mov_b32 v251, 1
  s_mov_b64 exec, 1
  ds_add_u32 v250, v251
  s_mov_b64 exec, -1
  s_branch k_a_go
k_a_w:
  v_mov_b32 v250, 36896
  s_mov_b32 s14, 0
lw_21:
  ds_read_b32 v251, v250
  s_add_u32 s14, s14, 1
  s_waitcnt lgkmcnt(0)
  v_readfirstlane_b32 s15, v251
  s_cmp_gt_u32 s14, 0x200000
  s_cbranch_scc1 lwe_22
  s_cmp_ge_u32 s15, 1
  s_cbranch_scc1 lwe_22
  s_sleep 1
  s_branch lw_21
lwe_22:
k_a_go:
  s_lshl_b32 s3, s72, 9
  s_lshl_b32 s11, s74, 7
  s_add_u32 s3, s3, s11
  s_add_u32 s3, s3, 16777216
  v_lshlrev_b32 v4, 2, v2
  buffer_load_dword v3, v4, s[44:47], s3 offen sc1
  s_branch k_att_first
k_att_start:
  v_mov_b32 v144, 0
  v_mov_b32 v145, 0
  v_mov_b32 v146, 0
  v_mov_b32 v147, 0
  s_nop 1
  v_mfma_f32_32x32x16_bf16 v[40:55], v[144:147], v[144:147], 0
  v_mfma_f32_32x32x16_bf16 v[56:71], v[144:147], v[144:147], 0
  v_mfma_f32_32x32x16_bf16 v[72:87], v[144:147], v[144:147], 0
  v_mfma_f32_32x32x16_bf16 v[88:103], v[144:147], v[144:147], 0
k_att_first:
  s_mov_b32 s6, 0
  s_mov_b32 s8, 0
  buffer_load_dwordx4 v[152:155], v7, s[48:51], s6 offen sc1
  buffer_load_dwordx4 v[156:159], v7, s[48:51], s6 offen offset:1024 sc1
  s_add_u32 s6, s6, 4096
  buffer_load_dwordx4 v[160:163], v7, s[48:51], s8 offen offset:2048 sc1
  buffer_load_dwordx4 v[164:167], v7, s[48:51], s8 offen offset:3072 sc1
  s_add_u32 s8, s8, 4096
  buffer_load_dwordx4 v[168:171], v7, s[48:51], s6 offen sc1
  buffer_load_dwordx4 v[172:175], v7, s[48:51], s6 offen offset:1024 sc1
  s_add_u32 s6, s6, 4096
  s_and_b32 s3, s72, 7
  s_lshl_b32 s3, s3, 7
  v_lshlrev_b32 v4, 10, v0
  buffer_load_dword v6, v4, s[48:51], s3 offen sc1
  s_lshl_b32 s3, s74, 2
  s_add_u32 s3, s3, 36928
  v_mov_b32 v248, s3
  v_mov_b32 v249, 1
  s_mov_b32 s77, 0
  s_add_u32 s3, s74, 1
  s_and_b32 s3, s3, 3
  s_mul_i32 s11, s3, 12288
  s_cmp_eq_u32 s3, 3
  s_cselect_b32 s11, 139264, s11
  v_add_u32 v250, s11, v7
  s_add_u32 s3, s74, 2
  s_and_b32 s3, s3, 3
  s_mul_i32 s11, s3, 12288
  s_cmp_eq_u32 s3, 3
  s_cselect_b32 s11, 139264, s11
  v_add_u32 v251, s11, v7
  s_add_u32 s3, s74, 3
  s_and_b32 s3, s3, 3
  s_mul_i32 s11, s3, 12288
  s_cmp_eq_u32 s3, 3
  s_cselect_b32 s11, 139264, s11
  v_add_u32 v252, s11, v7
  ds_write_b32 v248, v249
  v_mov_b32 v249, 2
  s_waitcnt vmcnt(5) lgkmcnt(0)
  v_mfma_f32_32x32x16_bf16 v[104:119], v[152:155], v[8:11], 0
  v_mfma_f32_32x32x16_bf16 v[104:119], v[156:159], v[12:15], v[104:119]
  s_setprio 1
  s_nop 13
  v_mfma_f32_32x32x16_bf16 v[120:135], v[152:155], v[16:19], 0
  v_exp_f32 v104, v104
  v_exp_f32 v105, v105
  v_exp_f32 v106, v106
  v_exp_f32 v107, v107
  v_mfma_f32_32x32x16_bf16 v[120:135], v[156:159], v[20:23], v[120:135]
  v_exp_f32 v108, v108
  v_exp_f32 v109, v109
  v_exp_f32 v110, v110
  v_exp_f32 v111, v111
  v_cvt_pk_bf16_f32 v136, v104, v105
  v_cvt_pk_bf16_f32 v137, v106, v107
  v_exp_f32 v112, v112
  v_exp_f32 v113, v113
  v_exp_f32 v114, v114
  v_exp_f32 v115, v115
  v_cvt_pk_bf16_f32 v138, v108, v109
  v_cvt_pk_bf16_f32 v139, v110, v111
  buffer_load_dwordx4 v[176:179], v7, s[48:51], s8 offen offset:2048 sc1
  buffer_load_dwordx4 v[180:183], v7, s[48:51], s8 offen offset:3072 sc1
  s_add_u32 s8, s8, 4096
  v_exp_f32 v116, v116
  v_exp_f32 v117, v117
  v_exp_f32 v118, v118
  v_exp_f32 v119, v119
  v_cvt_pk_bf16_f32 v140, v112, v113
  v_cvt_pk_bf16_f32 v141, v114, v115
  v_cvt_pk_bf16_f32 v142, v116, v117
  v_cvt_pk_bf16_f32 v143, v118, v119
  v_mfma_f32_32x32x16_bf16 v[104:119], v[152:155], v[24:27], 0
  v_exp_f32 v120, v120
  v_exp_f32 v121, v121
  v_exp_f32 v122, v122
  v_exp_f32 v123, v123
  v_mfma_f32_32x32x16_bf16 v[104:119], v[156:159], v[28:31], v[104:119]
  v_exp_f32 v124, v124
  v_exp_f32 v125, v125
  v_exp_f32 v126, v126
  v_exp_f32 v127, v127
  v_cvt_pk_bf16_f32 v144, v120, v121
  v_cvt_pk_bf16_f32 v145, v122, v123
  s_waitcnt vmcnt(5)
  v_mfma_f32_32x32x16_bf16 v[40:55], v[160:163], v[136:139], v[40:55]
  v_exp_f32 v128, v128
  v_exp_f32 v129, v129
  v_exp_f32 v130, v130
  v_exp_f32 v131, v131
  v_cvt_pk_bf16_f32 v146, v124, v125
  v_cvt_pk_bf16_f32 v147, v126, v127
  v_mfma_f32_32x32x16_bf16 v[40:55], v[164:167], v[140:143], v[40:55]
  buffer_load_dwordx4 v[184:187], v7, s[48:51], s6 offen sc1
  buffer_load_dwordx4 v[188:191], v7, s[48:51], s6 offen offset:1024 sc1
  s_add_u32 s6, s6, 4096
  v_exp_f32 v132, v132
  v_exp_f32 v133, v133
  v_exp_f32 v134, v134
  v_exp_f32 v135, v135
  v_cvt_pk_bf16_f32 v148, v128, v129
  v_cvt_pk_bf16_f32 v149, v130, v131
  v_cvt_pk_bf16_f32 v150, v132, v133
  v_cvt_pk_bf16_f32 v151, v134, v135
  v_mfma_f32_32x32x16_bf16 v[120:135], v[152:155], v[32:35], 0
  v_exp_f32 v104, v104
  v_exp_f32 v105, v105
  v_exp_f32 v106, v106
  v_exp_f32 v107, v107
  v_mfma_f32_32x32x16_bf16 v[120:135], v[156:159], v[36:39], v[120:135]
  v_exp_f32 v108, v108
  v_exp_f32 v109, v109
  v_exp_f32 v110, v110
  v_exp_f32 v111, v111
  v_cvt_pk_bf16_f32 v136, v104, v105
  v_cvt_pk_bf16_f32 v137, v106, v107
  v_mfma_f32_32x32x16_bf16 v[56:71], v[160:163], v[144:147], v[56:71]
  v_exp_f32 v112, v112
  v_exp_f32 v113, v113
  v_exp_f32 v114, v114
  v_exp_f32 v115, v115
  v_cvt_pk_bf16_f32 v138, v108, v109
  v_cvt_pk_bf16_f32 v139, v110, v111
  v_mfma_f32_32x32x16_bf16 v[56:71], v[164:167], v[148:151], v[56:71]
  buffer_load_dwordx4 v[192:195], v7, s[48:51], s8 offen offset:2048 sc1
  buffer_load_dwordx4 v[196:199], v7, s[48:51], s8 offen offset:3072 sc1
  s_add_u32 s8, s8, 4096
  v_exp_f32 v116, v116
  v_exp_f32 v117, v117
  v_exp_f32 v118, v118
  v_exp_f32 v119, v119
  v_cvt_pk_bf16_f32 v140, v112, v113
  v_cvt_pk_bf16_f32 v141, v114, v115
  v_cvt_pk_bf16_f32 v142, v116, v117
  v_cvt_pk_bf16_f32 v143, v118, v119
  s_waitcnt vmcnt(7)
  v_mfma_f32_32x32x16_bf16 v[104:119], v[168:171], v[8:11], 0
  v_exp_f32 v120, v120
  v_exp_f32 v121, v121
  v_exp_f32 v122, v122
  v_exp_f32 v123, v123
  v_mfma_f32_32x32x16_bf16 v[104:119], v[172:175], v[12:15], v[104:119]
  v_exp_f32 v124, v124
  v_exp_f32 v125, v125
  v_exp_f32 v126, v126
  v_exp_f32 v127, v127
  v_cvt_pk_bf16_f32 v144, v120, v121
  v_cvt_pk_bf16_f32 v145, v122, v123
  v_mfma_f32_32x32x16_bf16 v[72:87], v[160:163], v[136:139], v[72:87]
  v_exp_f32 v128, v128
  v_exp_f32 v129, v129
  v_exp_f32 v130, v130
  v_exp_f32 v131, v131
  v_cvt_pk_bf16_f32 v146, v124, v125
  v_cvt_pk_bf16_f32 v147, v126, v127
  v_mfma_f32_32x32x16_bf16 v[72:87], v[164:167], v[140:143], v[72:87]
  buffer_load_dwordx4 v[200:203], v7, s[48:51], s6 offen sc1
  buffer_load_dwordx4 v[204:207], v7, s[48:51], s6 offen offset:1024 sc1
  s_add_u32 s6, s6, 4096
  v_exp_f32 v132, v132
  v_exp_f32 v133, v133
  v_exp_f32 v134, v134
  v_exp_f32 v135, v135
  v_cvt_pk_bf16_f32 v148, v128, v129
  v_cvt_pk_bf16_f32 v149, v130, v131
  v_cvt_pk_bf16_f32 v150, v132, v133
  v_cvt_pk_bf16_f32 v151, v134, v135
  v_mfma_f32_32x32x16_bf16 v[120:135], v[168:171], v[16:19], 0
  v_exp_f32 v104, v104
  v_exp_f32 v105, v105
  v_exp_f32 v106, v106
  v_exp_f32 v107, v107
  v_mfma_f32_32x32x16_bf16 v[120:135], v[172:175], v[20:23], v[120:135]
  v_exp_f32 v108, v108
  v_exp_f32 v109, v109
  v_exp_f32 v110, v110
  v_exp_f32 v111, v111
  v_cvt_pk_bf16_f32 v136, v104, v105
  v_cvt_pk_bf16_f32 v137, v106, v107
  v_mfma_f32_32x32x16_bf16 v[88:103], v[160:163], v[144:147], v[88:103]
  v_exp_f32 v112, v112
  v_exp_f32 v113, v113
  v_exp_f32 v114, v114
  v_exp_f32 v115, v115
  v_cvt_pk_bf16_f32 v138, v108, v109
  v_cvt_pk_bf16_f32 v139, v110, v111
  v_mfma_f32_32x32x16_bf16 v[88:103], v[164:167], v[148:151], v[88:103]
  buffer_load_dwordx4 v[208:211], v7, s[48:51], s8 offen offset:2048 sc1
  buffer_load_dwordx4 v[212:215], v7, s[48:51], s8 offen offset:3072 sc1
  s_add_u32 s8, s8, 4096
  v_exp_f32 v116, v116
  v_exp_f32 v117, v117
  v_exp_f32 v118, v118
  v_exp_f32 v119, v119
  v_cvt_pk_bf16_f32 v140, v112, v113
  v_cvt_pk_bf16_f32 v141, v114, v115
  v_cvt_pk_bf16_f32 v142, v116, v117
  v_cvt_pk_bf16_f32 v143, v118, v119
  v_mfma_f32_32x32x16_bf16 v[104:119], v[168:171], v[24:27], 0
  v_exp_f32 v120, v120
  v_exp_f32 v121, v121
  v_exp_f32 v122, v122
  v_exp_f32 v123, v123
  v_mfma_f32_32x32x16_bf16 v[104:119], v[172:175], v[28:31], v[104:119]
  v_exp_f32 v124, v124
  v_exp_f32 v125, v125
  v_exp_f32 v126, v126
  v_exp_f32 v127, v127
  v_cvt_pk_bf16_f32 v144, v120, v121
  v_cvt_pk_bf16_f32 v145, v122, v123
  s_waitcnt vmcnt(8)
  v_mfma_f32_32x32x16_bf16 v[40:55], v[176:179], v[136:139], v[40:55]
  v_exp_f32 v128, v128
  v_exp_f32 v129, v129
  v_exp_f32 v130, v130
  v_exp_f32 v131, v131
  v_cvt_pk_bf16_f32 v146, v124, v125
  v_cvt_pk_bf16_f32 v147, v126, v127
  v_mfma_f32_32x32x16_bf16 v[40:55], v[180:183], v[140:143], v[40:55]
  buffer_load_dwordx4 v[216:219], v7, s[48:51], s6 offen sc1
  buffer_load_dwordx4 v[220:223], v7, s[48:51], s6 offen offset:1024 sc1
  s_add_u32 s6, s6, 4096
  v_exp_f32 v132, v132
  v_exp_f32 v133, v133
  v_exp_f32 v134, v134
  v_exp_f32 v135, v135
  v_cvt_pk_bf16_f32 v148, v128, v129
  v_cvt_pk_bf16_f32 v149, v130, v131
  v_cvt_pk_bf16_f32 v150, v132, v133
  v_cvt_pk_bf16_f32 v151, v134, v135
  v_mfma_f32_32x32x16_bf16 v[120:135], v[168:171], v[32:35], 0
  v_exp_f32 v104, v104
  v_exp_f32 v105, v105
  v_exp_f32 v106, v106
  v_exp_f32 v107, v107
  v_mfma_f32_32x32x16_bf16 v[120:135], v[172:175], v[36:39], v[120:135]
  v_exp_f32 v108, v108
  v_exp_f32 v109, v109
  v_exp_f32 v110, v110
  v_exp_f32 v111, v111
  v_cvt_pk_bf16_f32 v136, v104, v105
  v_cvt_pk_bf16_f32 v137, v106, v107
  v_mfma_f32_32x32x16_bf16 v[56:71], v[176:179], v[144:147], v[56:71]
  v_exp_f32 v112, v112
  v_exp_f32 v113, v113
  v_exp_f32 v114, v114
  v_exp_f32 v115, v115
  v_cvt_pk_bf16_f32 v138, v108, v109
  v_cvt_pk_bf16_f32 v139, v110, v111
  v_mfma_f32_32x32x16_bf16 v[56:71], v[180:183], v[148:151], v[56:71]
  buffer_load_dwordx4 v[224:227], v7, s[48:51], s8 offen offset:2048 sc1
  buffer_load_dwordx4 v[228:231], v7, s[48:51], s8 offen offset:3072 sc1
  s_add_u32 s8, s8, 4096
  v_exp_f32 v116, v116
  v_exp_f32 v117, v117
  v_exp_f32 v118, v118
  v_exp_f32 v119, v119
  v_cvt_pk_bf16_f32 v140, v112, v113
  v_cvt_pk_bf16_f32 v141, v114, v115
  v_cvt_pk_bf16_f32 v142, v116, v117
  v_cvt_pk_bf16_f32 v143, v118, v119
  s_waitcnt vmcnt(10)
  v_mfma_f32_32x32x16_bf16 v[104:119], v[184:187], v[8:11], 0
  v_exp_f32 v120, v120
  v_exp_f32 v121, v121
  v_exp_f32 v122, v122
  v_exp_f32 v123, v123
  v_mfma_f32_32x32x16_bf16 v[104:119], v[188:191], v[12:15], v[104:119]
  v_exp_f32 v124, v124
  v_exp_f32 v125, v125
  v_exp_f32 v126, v126
  v_exp_f32 v127, v127
  v_cvt_pk_bf16_f32 v144, v120, v121
  v_cvt_pk_bf16_f32 v145, v122, v123
  v_mfma_f32_32x32x16_bf16 v[72:87], v[176:179], v[136:139], v[72:87]
  v_exp_f32 v128, v128
  v_exp_f32 v129, v129
  v_exp_f32 v130, v130
  v_exp_f32 v131, v131
  v_cvt_pk_bf16_f32 v146, v124, v125
  v_cvt_pk_bf16_f32 v147, v126, v127
  v_mfma_f32_32x32x16_bf16 v[72:87], v[180:183], v[140:143], v[72:87]
  buffer_load_dwordx4 v[232:235], v7, s[48:51], s6 offen sc1
  buffer_load_dwordx4 v[236:239], v7, s[48:51], s6 offen offset:1024 sc1
  s_add_u32 s6, s6, 4096
  v_exp_f32 v132, v132
  v_exp_f32 v133, v133
  v_exp_f32 v134, v134
  v_exp_f32 v135, v135
  v_cvt_pk_bf16_f32 v148, v128, v129
  v_cvt_pk_bf16_f32 v149, v130, v131
  v_cvt_pk_bf16_f32 v150, v132, v133
  v_cvt_pk_bf16_f32 v151, v134, v135
  v_mfma_f32_32x32x16_bf16 v[120:135], v[184:187], v[16:19], 0
  v_exp_f32 v104, v104
  v_exp_f32 v105, v105
  v_exp_f32 v106, v106
  v_exp_f32 v107, v107
  v_mfma_f32_32x32x16_bf16 v[120:135], v[188:191], v[20:23], v[120:135]
  v_exp_f32 v108, v108
  v_exp_f32 v109, v109
  v_exp_f32 v110, v110
  v_exp_f32 v111, v111
  v_cvt_pk_bf16_f32 v136, v104, v105
  v_cvt_pk_bf16_f32 v137, v106, v107
  v_mfma_f32_32x32x16_bf16 v[88:103], v[176:179], v[144:147], v[88:103]
  v_exp_f32 v112, v112
  v_exp_f32 v113, v113
  v_exp_f32 v114, v114
  v_exp_f32 v115, v115
  v_cvt_pk_bf16_f32 v138, v108, v109
  v_cvt_pk_bf16_f32 v139, v110, v111
  v_mfma_f32_32x32x16_bf16 v[88:103], v[180:183], v[148:151], v[88:103]
  buffer_load_dwordx4 v[240:243], v7, s[48:51], s8 offen offset:2048 sc1
  buffer_load_dwordx4 v[244:247], v7, s[48:51], s8 offen offset:3072 sc1
  s_add_u32 s8, s8, 4096
  v_exp_f32 v116, v116
  v_exp_f32 v117, v117
  v_exp_f32 v118, v118
  v_exp_f32 v119, v119
  v_cvt_pk_bf16_f32 v140, v112, v113
  v_cvt_pk_bf16_f32 v141, v114, v115
  v_cvt_pk_bf16_f32 v142, v116, v117
  v_cvt_pk_bf16_f32 v143, v118, v119
  v_mfma_f32_32x32x16_bf16 v[104:119], v[184:187], v[24:27], 0
  v_exp_f32 v120, v120
  v_exp_f32 v121, v121
  v_exp_f32 v122, v122
  v_exp_f32 v123, v123
  v_mfma_f32_32x32x16_bf16 v[104:119], v[188:191], v[28:31], v[104:119]
  v_exp_f32 v124, v124
  v_exp_f32 v125, v125
  v_exp_f32 v126, v126
  v_exp_f32 v127, v127
  v_cvt_pk_bf16_f32 v144, v120, v121
  v_cvt_pk_bf16_f32 v145, v122, v123
  s_waitcnt vmcnt(12)
  v_mfma_f32_32x32x16_bf16 v[40:55], v[192:195], v[136:139], v[40:55]
  v_exp_f32 v128, v128
  v_exp_f32 v129, v129
  v_exp_f32 v130, v130
  v_exp_f32 v131, v131
  v_cvt_pk_bf16_f32 v146, v124, v125
  v_cvt_pk_bf16_f32 v147, v126, v127
  v_mfma_f32_32x32x16_bf16 v[40:55], v[196:199], v[140:143], v[40:55]
  buffer_load_dwordx4 v[152:155], v7, s[48:51], s6 offen sc1
  buffer_load_dwordx4 v[156:159], v7, s[48:51], s6 offen offset:1024 sc1
  s_add_u32 s6, s6, 4096
  v_exp_f32 v132, v132
  v_exp_f32 v133, v133
  v_exp_f32 v134, v134
  v_exp_f32 v135, v135
  v_cvt_pk_bf16_f32 v148, v128, v129
  v_cvt_pk_bf16_f32 v149, v130, v131
  v_cvt_pk_bf16_f32 v150, v132, v133
  v_cvt_pk_bf16_f32 v151, v134, v135
  v_mfma_f32_32x32x16_bf16 v[120:135], v[184:187], v[32:35], 0
  v_exp_f32 v104, v104
  v_exp_f32 v105, v105
  v_exp_f32 v106, v106
  v_exp_f32 v107, v107
  v_mfma_f32_32x32x16_bf16 v[120:135], v[188:191], v[36:39], v[120:135]
  v_exp_f32 v108, v108
  v_exp_f32 v109, v109
  v_exp_f32 v110, v110
  v_exp_f32 v111, v111
  v_cvt_pk_bf16_f32 v136, v104, v105
  v_cvt_pk_bf16_f32 v137, v106, v107
  v_mfma_f32_32x32x16_bf16 v[56:71], v[192:195], v[144:147], v[56:71]
  v_exp_f32 v112, v112
  v_exp_f32 v113, v113
  v_exp_f32 v114, v114
  v_exp_f32 v115, v115
  v_cvt_pk_bf16_f32 v138, v108, v109
  v_cvt_pk_bf16_f32 v139, v110, v111
  v_mfma_f32_32x32x16_bf16 v[56:71], v[196:199], v[148:151], v[56:71]
  buffer_load_dwordx4 v[160:163], v7, s[48:51], s8 offen offset:2048 sc1
  buffer_load_dwordx4 v[164:167], v7, s[48:51], s8 offen offset:3072 sc1
  s_add_u32 s8, s8, 4096
  v_exp_f32 v116, v116
  v_exp_f32 v117, v117
  v_exp_f32 v118, v118
  v_exp_f32 v119, v119
  v_cvt_pk_bf16_f32 v140, v112, v113
  v_cvt_pk_bf16_f32 v141, v114, v115
  v_cvt_pk_bf16_f32 v142, v116, v117
  v_cvt_pk_bf16_f32 v143, v118, v119
  s_waitcnt vmcnt(14)
  v_mfma_f32_32x32x16_bf16 v[104:119], v[200:203], v[8:11], 0
  v_exp_f32 v120, v120
  v_exp_f32 v121, v121
  v_exp_f32 v122, v122
  v_exp_f32 v123, v123
  v_mfma_f32_32x32x16_bf16 v[104:119], v[204:207], v[12:15], v[104:119]
  v_exp_f32 v124, v124
  v_exp_f32 v125, v125
  v_exp_f32 v126, v126
  v_exp_f32 v127, v127
  v_cvt_pk_bf16_f32 v144, v120, v121
  v_cvt_pk_bf16_f32 v145, v122, v123
  v_mfma_f32_32x32x16_bf16 v[72:87], v[192:195], v[136:139], v[72:87]
  v_exp_f32 v128, v128
  v_exp_f32 v129, v129
  v_exp_f32 v130, v130
  v_exp_f32 v131, v131
  v_cvt_pk_bf16_f32 v146, v124, v125
  v_cvt_pk_bf16_f32 v147, v126, v127
  v_mfma_f32_32x32x16_bf16 v[72:87], v[196:199], v[140:143], v[72:87]
  buffer_load_dwordx4 v[168:171], v7, s[48:51], s6 offen sc1
  buffer_load_dwordx4 v[172:175], v7, s[48:51], s6 offen offset:1024 sc1
  s_add_u32 s6, s6, 4096
  v_exp_f32 v132, v132
  v_exp_f32 v133, v133
  v_exp_f32 v134, v134
  v_exp_f32 v135, v135
  v_cvt_pk_bf16_f32 v148, v128, v129
  v_cvt_pk_bf16_f32 v149, v130, v131
  v_cvt_pk_bf16_f32 v150, v132, v133
  v_cvt_pk_bf16_f32 v151, v134, v135
  v_mfma_f32_32x32x16_bf16 v[120:135], v[200:203], v[16:19], 0
  v_exp_f32 v104, v104
  v_exp_f32 v105, v105
  v_exp_f32 v106, v106
  v_exp_f32 v107, v107
  v_mfma_f32_32x32x16_bf16 v[120:135], v[204:207], v[20:23], v[120:135]
  v_exp_f32 v108, v108
  v_exp_f32 v109, v109
  v_exp_f32 v110, v110
  v_exp_f32 v111, v111
  v_cvt_pk_bf16_f32 v136, v104, v105
  v_cvt_pk_bf16_f32 v137, v106, v107
  v_mfma_f32_32x32x16_bf16 v[88:103], v[192:195], v[144:147], v[88:103]
  v_exp_f32 v112, v112
  v_exp_f32 v113, v113
  v_exp_f32 v114, v114
  v_exp_f32 v115, v115
  v_cvt_pk_bf16_f32 v138, v108, v109
  v_cvt_pk_bf16_f32 v139, v110, v111
  v_mfma_f32_32x32x16_bf16 v[88:103], v[196:199], v[148:151], v[88:103]
  buffer_load_dwordx4 v[176:179], v7, s[48:51], s8 offen offset:2048 sc1
  buffer_load_dwordx4 v[180:183], v7, s[48:51], s8 offen offset:3072 sc1
  s_add_u32 s8, s8, 4096
  v_exp_f32 v116, v116
  v_exp_f32 v117, v117
  v_exp_f32 v118, v118
  v_exp_f32 v119, v119
  v_cvt_pk_bf16_f32 v140, v112, v113
  v_cvt_pk_bf16_f32 v141, v114, v115
  v_cvt_pk_bf16_f32 v142, v116, v117
  v_cvt_pk_bf16_f32 v143, v118, v119
  v_mfma_f32_32x32x16_bf16 v[104:119], v[200:203], v[24:27], 0
  v_exp_f32 v120, v120
  v_exp_f32 v121, v121
  v_exp_f32 v122, v122
  v_exp_f32 v123, v123
  v_mfma_f32_32x32x16_bf16 v[104:119], v[204:207], v[28:31], v[104:119]
  v_exp_f32 v124, v124
  v_exp_f32 v125, v125
  v_exp_f32 v126, v126
  v_exp_f32 v127, v127
  v_cvt_pk_bf16_f32 v144, v120, v121
  v_cvt_pk_bf16_f32 v145, v122, v123
  s_waitcnt vmcnt(16)
  v_mfma_f32_32x32x16_bf16 v[40:55], v[208:211], v[136:139], v[40:55]
  v_exp_f32 v128, v128
  v_exp_f32 v129, v129
  v_exp_f32 v130, v130
  v_exp_f32 v131, v131
  v_cvt_pk_bf16_f32 v146, v124, v125
  v_cvt_pk_bf16_f32 v147, v126, v127
  v_mfma_f32_32x32x16_bf16 v[40:55], v[212:215], v[140:143], v[40:55]
  buffer_load_dwordx4 v[184:187], v7, s[48:51], s6 offen sc1
  buffer_load_dwordx4 v[188:191], v7, s[48:51], s6 offen offset:1024 sc1
  s_add_u32 s6, s6, 4096
  v_exp_f32 v132, v132
  v_exp_f32 v133, v133
  v_exp_f32 v134, v134
  v_exp_f32 v135, v135
  v_cvt_pk_bf16_f32 v148, v128, v129
  v_cvt_pk_bf16_f32 v149, v130, v131
  v_cvt_pk_bf16_f32 v150, v132, v133
  v_cvt_pk_bf16_f32 v151, v134, v135
  ds_write_b32 v248, v249
  v_mov_b32 v249, 3
  v_mfma_f32_32x32x16_bf16 v[120:135], v[200:203], v[32:35], 0
  v_exp_f32 v104, v104
  v_exp_f32 v105, v105
  v_exp_f32 v106, v106
  v_exp_f32 v107, v107
  v_mfma_f32_32x32x16_bf16 v[120:135], v[204:207], v[36:39], v[120:135]
  v_exp_f32 v108, v108
  v_exp_f32 v109, v109
  v_exp_f32 v110, v110
  v_exp_f32 v111, v111
  v_cvt_pk_bf16_f32 v136, v104, v105
  v_cvt_pk_bf16_f32 v137, v106, v107
  v_mfma_f32_32x32x16_bf16 v[56:71], v[208:211], v[144:147], v[56:71]
  v_exp_f32 v112, v112
  v_exp_f32 v113, v113
  v_exp_f32 v114, v114
  v_exp_f32 v115, v115
  v_cvt_pk_bf16_f32 v138, v108, v109
  v_cvt_pk_bf16_f32 v139, v110, v111
  v_mfma_f32_32x32x16_bf16 v[56:71], v[212:215], v[148:151], v[56:71]
  buffer_load_dwordx4 v[192:195], v7, s[48:51], s8 offen offset:2048 sc1
  buffer_load_dwordx4 v[196:199], v7, s[48:51], s8 offen offset:3072 sc1
  s_add_u32 s8, s8, 4096
  v_exp_f32 v116, v116
  v_exp_f32 v117, v117
  v_exp_f32 v118, v118
  v_exp_f32 v119, v119
  v_cvt_pk_bf16_f32 v140, v112, v113
  v_cvt_pk_bf16_f32 v141, v114, v115
  v_cvt_pk_bf16_f32 v142, v116, v117
  v_cvt_pk_bf16_f32 v143, v118, v119
  s_waitcnt vmcnt(18)
  v_mfma_f32_32x32x16_bf16 v[104:119], v[216:219], v[8:11], 0
  v_exp_f32 v120, v120
  v_exp_f32 v121, v121
  v_exp_f32 v122, v122
  v_exp_f32 v123, v123
  v_mfma_f32_32x32x16_bf16 v[104:119], v[220:223], v[12:15], v[104:119]
  v_exp_f32 v124, v124
  v_exp_f32 v125, v125
  v_exp_f32 v126, v126
  v_exp_f32 v127, v127
  v_cvt_pk_bf16_f32 v144, v120, v121
  v_cvt_pk_bf16_f32 v145, v122, v123
  v_mfma_f32_32x32x16_bf16 v[72:87], v[208:211], v[136:139], v[72:87]
  v_exp_f32 v128, v128
  v_exp_f32 v129, v129
  v_exp_f32 v130, v130
  v_exp_f32 v131, v131
  v_cvt_pk_bf16_f32 v146, v124, v125
  v_cvt_pk_bf16_f32 v147, v126, v127
  v_mfma_f32_32x32x16_bf16 v[72:87], v[212:215], v[140:143], v[72:87]
  buffer_load_dwordx4 v[200:203], v7, s[48:51], s6 offen sc1
  buffer_load_dwordx4 v[204:207], v7, s[48:51], s6 offen offset:1024 sc1
  s_add_u32 s6, s6, 4096
  v_exp_f32 v132, v132
  v_exp_f32 v133, v133
  v_exp_f32 v134, v134
  v_exp_f32 v135, v135
  v_cvt_pk_bf16_f32 v148, v128, v129
  v_cvt_pk_bf16_f32 v149, v130, v131
  v_cvt_pk_bf16_f32 v150, v132, v133
  v_cvt_pk_bf16_f32 v151, v134, v135
  v_mfma_f32_32x32x16_bf16 v[120:135], v[216:219], v[16:19], 0
  v_exp_f32 v104, v104
  v_exp_f32 v105, v105
  v_exp_f32 v106, v106
  v_exp_f32 v107, v107
  v_mfma_f32_32x32x16_bf16 v[120:135], v[220:223], v[20:23], v[120:135]
  v_exp_f32 v108, v108
  v_exp_f32 v109, v109
  v_exp_f32 v110, v110
  v_exp_f32 v111, v111
  v_cvt_pk_bf16_f32 v136, v104, v105
  v_cvt_pk_bf16_f32 v137, v106, v107
  v_mfma_f32_32x32x16_bf16 v[88:103], v[208:211], v[144:147], v[88:103]
  v_exp_f32 v112, v112
  v_exp_f32 v113, v113
  v_exp_f32 v114, v114
  v_exp_f32 v115, v115
  v_cvt_pk_bf16_f32 v138, v108, v109
  v_cvt_pk_bf16_f32 v139, v110, v111
  v_mfma_f32_32x32x16_bf16 v[88:103], v[212:215], v[148:151], v[88:103]
  buffer_load_dwordx4 v[208:211], v7, s[48:51], s8 offen offset:2048 sc1
  buffer_load_dwordx4 v[212:215], v7, s[48:51], s8 offen offset:3072 sc1
  s_add_u32 s8, s8, 4096
  v_exp_f32 v116, v116
  v_exp_f32 v117, v117
  v_exp_f32 v118, v118
  v_exp_f32 v119, v119
  v_cvt_pk_bf16_f32 v140, v112, v113
  v_cvt_pk_bf16_f32 v141, v114, v115
  v_cvt_pk_bf16_f32 v142, v116, v117
  v_cvt_pk_bf16_f32 v143, v118, v119
  v_mfma_f32_32x32x16_bf16 v[104:119], v[216:219], v[24:27], 0
  v_exp_f32 v120, v120
  v_exp_f32 v121, v121
  v_exp_f32 v122, v122
  v_exp_f32 v123, v123
  v_mfma_f32_32x32x16_bf16 v[104:119], v[220:223], v[28:31], v[104:119]
  v_exp_f32 v124, v124
  v_exp_f32 v125, v125
  v_exp_f32 v126, v126
  v_exp_f32 v127, v127
  v_cvt_pk_bf16_f32 v144, v120, v121
  v_cvt_pk_bf16_f32 v145, v122, v123
  s_waitcnt vmcnt(20)
  v_mfma_f32_32x32x16_bf16 v[40:55], v[224:227], v[136:139], v[40:55]
  v_exp_f32 v128, v128
  v_exp_f32 v129, v129
  v_exp_f32 v130, v130
  v_exp_f32 v131, v131
  v_cvt_pk_bf16_f32 v146, v124, v125
  v_cvt_pk_bf16_f32 v147, v126, v127
  v_mfma_f32_32x32x16_bf16 v[40:55], v[228:231], v[140:143], v[40:55]
  v_exp_f32 v132, v132
  v_exp_f32 v133, v133
  v_exp_f32 v134, v134
  v_exp_f32 v135, v135
  v_cvt_pk_bf16_f32 v148, v128, v129
  v_cvt_pk_bf16_f32 v149, v130, v131
  v_cvt_pk_bf16_f32 v150, v132, v133
  v_cvt_pk_bf16_f32 v151, v134, v135
  v_mfma_f32_32x32x16_bf16 v[120:135], v[216:219], v[32:35], 0
  v_exp_f32 v104, v104
  v_exp_f32 v105, v105
  v_exp_f32 v106, v106
  v_exp_f32 v107, v107
  v_mfma_f32_32x32x16_bf16 v[120:135], v[220:223], v[36:39], v[120:135]
  v_exp_f32 v108, v108
  v_exp_f32 v109, v109
  v_exp_f32 v110, v110
  v_exp_f32 v111, v111
  v_cvt_pk_bf16_f32 v136, v104, v105
  v_cvt_pk_bf16_f32 v137, v106, v107
  v_mfma_f32_32x32x16_bf16 v[56:71], v[224:227], v[144:147], v[56:71]
  v_exp_f32 v112, v112
  v_exp_f32 v113, v113
  v_exp_f32 v114, v114
  v_exp_f32 v115, v115
  v_cvt_pk_bf16_f32 v138, v108, v109
  v_cvt_pk_bf16_f32 v139, v110, v111
  v_mfma_f32_32x32x16_bf16 v[56:71], v[228:231], v[148:151], v[56:71]
  buffer_load_dwordx4 v[216:219], v7, s[48:51], s6 offen sc1
  buffer_load_dwordx4 v[220:223], v7, s[48:51], s6 offen offset:1024 sc1
  s_add_u32 s6, s6, 4096
  v_exp_f32 v116, v116
  v_exp_f32 v117, v117
  v_exp_f32 v118, v118
  v_exp_f32 v119, v119
  v_cvt_pk_bf16_f32 v140, v112, v113
  v_cvt_pk_bf16_f32 v141, v114, v115
  v_cvt_pk_bf16_f32 v142, v116, v117
  v_cvt_pk_bf16_f32 v143, v118, v119
  s_waitcnt vmcnt(20)
  v_mfma_f32_32x32x16_bf16 v[104:119], v[232:235], v[8:11], 0
  v_exp_f32 v120, v120
  v_exp_f32 v121, v121
  v_exp_f32 v122, v122
  v_exp_f32 v123, v123
  v_mfma_f32_32x32x16_bf16 v[104:119], v[236:239], v[12:15], v[104:119]
  v_exp_f32 v124, v124
  v_exp_f32 v125, v125
  v_exp_f32 v126, v126
  v_exp_f32 v127, v127
  v_cvt_pk_bf16_f32 v144, v120, v121
  v_cvt_pk_bf16_f32 v145, v122, v123
  v_mfma_f32_32x32x16_bf16 v[72:87], v[224:227], v[136:139], v[72:87]
  v_exp_f32 v128, v128
  v_exp_f32 v129, v129
  v_exp_f32 v130, v130
  v_exp_f32 v131, v131
  v_cvt_pk_bf16_f32 v146, v124, v125
  v_cvt_pk_bf16_f32 v147, v126, v127
  v_mfma_f32_32x32x16_bf16 v[72:87], v[228:231], v[140:143], v[72:87]
  v_exp_f32 v132, v132
  v_exp_f32 v133, v133
  v_exp_f32 v134, v134
  v_exp_f32 v135, v135
  v_cvt_pk_bf16_f32 v148, v128, v129
  v_cvt_pk_bf16_f32 v149, v130, v131
  v_cvt_pk_bf16_f32 v150, v132, v133
  v_cvt_pk_bf16_f32 v151, v134, v135
  v_mfma_f32_32x32x16_bf16 v[120:135], v[232:235], v[16:19], 0
  v_exp_f32 v104, v104
  v_exp_f32 v105, v105
  v_exp_f32 v106, v106
  v_exp_f32 v107, v107
  v_mfma_f32_32x32x16_bf16 v[120:135], v[236:239], v[20:23], v[120:135]
  v_exp_f32 v108, v108
  v_exp_f32 v109, v109
  v_exp_f32 v110, v110
  v_exp_f32 v111, v111
  v_cvt_pk_bf16_f32 v136, v104, v105
  v_cvt_pk_bf16_f32 v137, v106, v107
  v_mfma_f32_32x32x16_bf16 v[88:103], v[224:227], v[144:147], v[88:103]
  v_exp_f32 v112, v112
  v_exp_f32 v113, v113
  v_exp_f32 v114, v114
  v_exp_f32 v115, v115
  v_cvt_pk_bf16_f32 v138, v108, v109
  v_cvt_pk_bf16_f32 v139, v110, v111
  v_mfma_f32_32x32x16_bf16 v[88:103], v[228:231], v[148:151], v[88:103]
  buffer_load_dwordx4 v[224:227], v7, s[48:51], s8 offen offset:2048 sc1
  buffer_load_dwordx4 v[228:231], v7, s[48:51], s8 offen offset:3072 sc1
  s_add_u32 s8, s8, 4096
  v_exp_f32 v116, v116
  v_exp_f32 v117, v117
  v_exp_f32 v118, v118
  v_exp_f32 v119, v119
  v_cvt_pk_bf16_f32 v140, v112, v113
  v_cvt_pk_bf16_f32 v141, v114, v115
  v_cvt_pk_bf16_f32 v142, v116, v117
  v_cvt_pk_bf16_f32 v143, v118, v119
  v_mfma_f32_32x32x16_bf16 v[104:119], v[232:235], v[24:27], 0
  v_exp_f32 v120, v120
  v_exp_f32 v121, v121
  v_exp_f32 v122, v122
  v_exp_f32 v123, v123
  v_mfma_f32_32x32x16_bf16 v[104:119], v[236:239], v[28:31], v[104:119]
  v_exp_f32 v124, v124
  v_exp_f32 v125, v125
  v_exp_f32 v126, v126
  v_exp_f32 v127, v127
  v_cvt_pk_bf16_f32 v144, v120, v121
  v_cvt_pk_bf16_f32 v145, v122, v123
  s_waitcnt vmcnt(20)
  v_mfma_f32_32x32x16_bf16 v[40:55], v[240:243], v[136:139], v[40:55]
  v_exp_f32 v128, v128
  v_exp_f32 v129, v129
  v_exp_f32 v130, v130
  v_exp_f32 v131, v131
  v_cvt_pk_bf16_f32 v146, v124, v125
  v_cvt_pk_bf16_f32 v147, v126, v127
  v_mfma_f32_32x32x16_bf16 v[40:55], v[244:247], v[140:143], v[40:55]
  v_exp_f32 v132, v132
  v_exp_f32 v133, v133
  v_exp_f32 v134, v134
  v_exp_f32 v135, v135
  v_cvt_pk_bf16_f32 v148, v128, v129
  v_cvt_pk_bf16_f32 v149, v130, v131
  v_cvt_pk_bf16_f32 v150, v132, v133
  v_cvt_pk_bf16_f32 v151, v134, v135
  v_mfma_f32_32x32x16_bf16 v[120:135], v[232:235], v[32:35], 0
  v_exp_f32 v104, v104
  v_exp_f32 v105, v105
  v_exp_f32 v106, v106
  v_exp_f32 v107, v107
  v_mfma_f32_32x32x16_bf16 v[120:135], v[236:239], v[36:39], v[120:135]
  v_exp_f32 v108, v108
  v_exp_f32 v109, v109
  v_exp_f32 v110, v110
  v_exp_f32 v111, v111
  v_cvt_pk_bf16_f32 v136, v104, v105
  v_cvt_pk_bf16_f32 v137, v106, v107
  v_mfma_f32_32x32x16_bf16 v[56:71], v[240:243], v[144:147], v[56:71]
  v_exp_f32 v112, v112
  v_exp_f32 v113, v113
  v_exp_f32 v114, v114
  v_exp_f32 v115, v115
  v_cvt_pk_bf16_f32 v138, v108, v109
  v_cvt_pk_bf16_f32 v139, v110, v111
  v_mfma_f32_32x32x16_bf16 v[56:71], v[244:247], v[148:151], v[56:71]
  buffer_load_dwordx4 v[232:235], v7, s[48:51], s6 offen sc1
  buffer_load_dwordx4 v[236:239], v7, s[48:51], s6 offen offset:1024 sc1
  s_add_u32 s6, s6, 4096
  v_exp_f32 v116, v116
  v_exp_f32 v117, v117
  v_exp_f32 v118, v118
  v_exp_f32 v119, v119
  v_cvt_pk_bf16_f32 v140, v112, v113
  v_cvt_pk_bf16_f32 v141, v114, v115
  v_cvt_pk_bf16_f32 v142, v116, v117
  v_cvt_pk_bf16_f32 v143, v118, v119
  s_waitcnt vmcnt(20)
  v_mfma_f32_32x32x16_bf16 v[104:119], v[152:155], v[8:11], 0
  v_exp_f32 v120, v120
  v_exp_f32 v121, v121
  v_exp_f32 v122, v122
  v_exp_f32 v123, v123
  v_mfma_f32_32x32x16_bf16 v[104:119], v[156:159], v[12:15], v[104:119]
  v_exp_f32 v124, v124
  v_exp_f32 v125, v125
  v_exp_f32 v126, v126
  v_exp_f32 v127, v127
  v_cvt_pk_bf16_f32 v144, v120, v121
  v_cvt_pk_bf16_f32 v145, v122, v123
  v_mfma_f32_32x32x16_bf16 v[72:87], v[240:243], v[136:139], v[72:87]
  v_exp_f32 v128, v128
  v_exp_f32 v129, v129
  v_exp_f32 v130, v130
  v_exp_f32 v131, v131
  v_cvt_pk_bf16_f32 v146, v124, v125
  v_cvt_pk_bf16_f32 v147, v126, v127
  v_mfma_f32_32x32x16_bf16 v[72:87], v[244:247], v[140:143], v[72:87]
  v_exp_f32 v132, v132
  v_exp_f32 v133, v133
  v_exp_f32 v134, v134
  v_exp_f32 v135, v135
  v_cvt_pk_bf16_f32 v148, v128, v129
  v_cvt_pk_bf16_f32 v149, v130, v131
  v_cvt_pk_bf16_f32 v150, v132, v133
  v_cvt_pk_bf16_f32 v151, v134, v135
  v_mfma_f32_32x32x16_bf16 v[120:135], v[152:155], v[16:19], 0
  v_exp_f32 v104, v104
  v_exp_f32 v105, v105
  v_exp_f32 v106, v106
  v_exp_f32 v107, v107
  v_mfma_f32_32x32x16_bf16 v[120:135], v[156:159], v[20:23], v[120:135]
  v_exp_f32 v108, v108
  v_exp_f32 v109, v109
  v_exp_f32 v110, v110
  v_exp_f32 v111, v111
  v_cvt_pk_bf16_f32 v136, v104, v105
  v_cvt_pk_bf16_f32 v137, v106, v107
  v_mfma_f32_32x32x16_bf16 v[88:103], v[240:243], v[144:147], v[88:103]
  v_exp_f32 v112, v112
  v_exp_f32 v113, v113
  v_exp_f32 v114, v114
  v_exp_f32 v115, v115
  v_cvt_pk_bf16_f32 v138, v108, v109
  v_cvt_pk_bf16_f32 v139, v110, v111
  v_mfma_f32_32x32x16_bf16 v[88:103], v[244:247], v[148:151], v[88:103]
  buffer_load_dwordx4 v[240:243], v7, s[48:51], s8 offen offset:2048 sc1
  buffer_load_dwordx4 v[244:247], v7, s[48:51], s8 offen offset:3072 sc1
  s_add_u32 s8, s8, 4096
  v_exp_f32 v116, v116
  v_exp_f32 v117, v117
  v_exp_f32 v118, v118
  v_exp_f32 v119, v119
  v_cvt_pk_bf16_f32 v140, v112, v113
  v_cvt_pk_bf16_f32 v141, v114, v115
  v_cvt_pk_bf16_f32 v142, v116, v117
  v_cvt_pk_bf16_f32 v143, v118, v119
  v_mfma_f32_32x32x16_bf16 v[104:119], v[152:155], v[24:27], 0
  v_exp_f32 v120, v120
  v_exp_f32 v121, v121
  v_exp_f32 v122, v122
  v_exp_f32 v123, v123
  v_mfma_f32_32x32x16_bf16 v[104:119], v[156:159], v[28:31], v[104:119]
  v_exp_f32 v124, v124
  v_exp_f32 v125, v125
  v_exp_f32 v126, v126
  v_exp_f32 v127, v127
  v_cvt_pk_bf16_f32 v144, v120, v121
  v_cvt_pk_bf16_f32 v145, v122, v123
  s_waitcnt vmcnt(20)
  v_mfma_f32_32x32x16_bf16 v[40:55], v[160:163], v[136:139], v[40:55]
  v_exp_f32 v128, v128
  v_exp_f32 v129, v129
  v_exp_f32 v130, v130
  v_exp_f32 v131, v131
  v_cvt_pk_bf16_f32 v146, v124, v125
  v_cvt_pk_bf16_f32 v147, v126, v127
  v_mfma_f32_32x32x16_bf16 v[40:55], v[164:167], v[140:143], v[40:55]
  v_exp_f32 v132, v132
  v_exp_f32 v133, v133
  v_exp_f32 v134, v134
  v_exp_f32 v135, v135
  v_cvt_pk_bf16_f32 v148, v128, v129
  v_cvt_pk_bf16_f32 v149, v130, v131
  v_cvt_pk_bf16_f32 v150, v132, v133
  v_cvt_pk_bf16_f32 v151, v134, v135
  v_mfma_f32_32x32x16_bf16 v[120:135], v[152:155], v[32:35], 0
  v_exp_f32 v104, v104
  v_exp_f32 v105, v105
  v_exp_f32 v106, v106
  v_exp_f32 v107, v107
  v_mfma_f32_32x32x16_bf16 v[120:135], v[156:159], v[36:39], v[120:135]
  v_exp_f32 v108, v108
  v_exp_f32 v109, v109
  v_exp_f32 v110, v110
  v_exp_f32 v111, v111
  v_cvt_pk_bf16_f32 v136, v104, v105
  v_cvt_pk_bf16_f32 v137, v106, v107
  v_mfma_f32_32x32x16_bf16 v[56:71], v[160:163], v[144:147], v[56:71]
  v_exp_f32 v112, v112
  v_exp_f32 v113, v113
  v_exp_f32 v114, v114
  v_exp_f32 v115, v115
  v_cvt_pk_bf16_f32 v138, v108, v109
  v_cvt_pk_bf16_f32 v139, v110, v111
  v_mfma_f32_32x32x16_bf16 v[56:71], v[164:167], v[148:151], v[56:71]
  buffer_load_dwordx4 v[152:155], v7, s[48:51], s6 offen sc1
  buffer_load_dwordx4 v[156:159], v7, s[48:51], s6 offen offset:1024 sc1
  s_add_u32 s6, s6, 4096
  v_exp_f32 v116, v116
  v_exp_f32 v117, v117
  v_exp_f32 v118, v118
  v_exp_f32 v119, v119
  v_cvt_pk_bf16_f32 v140, v112, v113
  v_cvt_pk_bf16_f32 v141, v114, v115
  v_cvt_pk_bf16_f32 v142, v116, v117
  v_cvt_pk_bf16_f32 v143, v118, v119
  s_waitcnt vmcnt(20)
  v_mfma_f32_32x32x16_bf16 v[104:119], v[168:171], v[8:11], 0
  v_exp_f32 v120, v120
  v_exp_f32 v121, v121
  v_exp_f32 v122, v122
  v_exp_f32 v123, v123
  v_mfma_f32_32x32x16_bf16 v[104:119], v[172:175], v[12:15], v[104:119]
  v_exp_f32 v124, v124
  v_exp_f32 v125, v125
  v_exp_f32 v126, v126
  v_exp_f32 v127, v127
  v_cvt_pk_bf16_f32 v144, v120, v121
  v_cvt_pk_bf16_f32 v145, v122, v123
  v_mfma_f32_32x32x16_bf16 v[72:87], v[160:163], v[136:139], v[72:87]
  v_exp_f32 v128, v128
  v_exp_f32 v129, v129
  v_exp_f32 v130, v130
  v_exp_f32 v131, v131
  v_cvt_pk_bf16_f32 v146, v124, v125
  v_cvt_pk_bf16_f32 v147, v126, v127
  v_mfma_f32_32x32x16_bf16 v[72:87], v[164:167], v[140:143], v[72:87]
  v_exp_f32 v132, v132
  v_exp_f32 v133, v133
  v_exp_f32 v134, v134
  v_exp_f32 v135, v135
  v_cvt_pk_bf16_f32 v148, v128, v129
  v_cvt_pk_bf16_f32 v149, v130, v131
  v_cvt_pk_bf16_f32 v150, v132, v133
  v_cvt_pk_bf16_f32 v151, v134, v135
  v_mfma_f32_32x32x16_bf16 v[120:135], v[168:171], v[16:19], 0
  v_exp_f32 v104, v104
  v_exp_f32 v105, v105
  v_exp_f32 v106, v106
  v_exp_f32 v107, v107
  v_mfma_f32_32x32x16_bf16 v[120:135], v[172:175], v[20:23], v[120:135]
  v_exp_f32 v108, v108
  v_exp_f32 v109, v109
  v_exp_f32 v110, v110
  v_exp_f32 v111, v111
  v_cvt_pk_bf16_f32 v136, v104, v105
  v_cvt_pk_bf16_f32 v137, v106, v107
  v_mfma_f32_32x32x16_bf16 v[88:103], v[160:163], v[144:147], v[88:103]
  v_exp_f32 v112, v112
  v_exp_f32 v113, v113
  v_exp_f32 v114, v114
  v_exp_f32 v115, v115
  v_cvt_pk_bf16_f32 v138, v108, v109
  v_cvt_pk_bf16_f32 v139, v110, v111
  v_mfma_f32_32x32x16_bf16 v[88:103], v[164:167], v[148:151], v[88:103]
  buffer_load_dwordx4 v[160:163], v7, s[48:51], s8 offen offset:2048 sc1
  buffer_load_dwordx4 v[164:167], v7, s[48:51], s8 offen offset:3072 sc1
  s_add_u32 s8, s8, 4096
  v_exp_f32 v116, v116
  v_exp_f32 v117, v117
  v_exp_f32 v118, v118
  v_exp_f32 v119, v119
  v_cvt_pk_bf16_f32 v140, v112, v113
  v_cvt_pk_bf16_f32 v141, v114, v115
  v_cvt_pk_bf16_f32 v142, v116, v117
  v_cvt_pk_bf16_f32 v143, v118, v119
  v_mfma_f32_32x32x16_bf16 v[104:119], v[168:171], v[24:27], 0
  v_exp_f32 v120, v120
  v_exp_f32 v121, v121
  v_exp_f32 v122, v122
  v_exp_f32 v123, v123
  v_mfma_f32_32x32x16_bf16 v[104:119], v[172:175], v[28:31], v[104:119]
  v_exp_f32 v124, v124
  v_exp_f32 v125, v125
  v_exp_f32 v126, v126
  v_exp_f32 v127, v127
  v_cvt_pk_bf16_f32 v144, v120, v121
  v_cvt_pk_bf16_f32 v145, v122, v123
  s_waitcnt vmcnt(20)
  v_mfma_f32_32x32x16_bf16 v[40:55], v[176:179], v[136:139], v[40:55]
  v_exp_f32 v128, v128
  v_exp_f32 v129, v129
  v_exp_f32 v130, v130
  v_exp_f32 v131, v131
  v_cvt_pk_bf16_f32 v146, v124, v125
  v_cvt_pk_bf16_f32 v147, v126, v127
  v_mfma_f32_32x32x16_bf16 v[40:55], v[180:183], v[140:143], v[40:55]
  v_exp_f32 v132, v132
  v_exp_f32 v133, v133
  v_exp_f32 v134, v134
  v_exp_f32 v135, v135
  v_cvt_pk_bf16_f32 v148, v128, v129
  v_cvt_pk_bf16_f32 v149, v130, v131
  v_cvt_pk_bf16_f32 v150, v132, v133
  v_cvt_pk_bf16_f32 v151, v134, v135
  v_mfma_f32_32x32x16_bf16 v[120:135], v[168:171], v[32:35], 0
  v_exp_f32 v104, v104
  v_exp_f32 v105, v105
  v_exp_f32 v106, v106
  v_exp_f32 v107, v107
  v_mfma_f32_32x32x16_bf16 v[120:135], v[172:175], v[36:39], v[120:135]
  v_exp_f32 v108, v108
  v_exp_f32 v109, v109
  v_exp_f32 v110, v110
  v_exp_f32 v111, v111
  v_cvt_pk_bf16_f32 v136, v104, v105
  v_cvt_pk_bf16_f32 v137, v106, v107
  v_mfma_f32_32x32x16_bf16 v[56:71], v[176:179], v[144:147], v[56:71]
  v_exp_f32 v112, v112
  v_exp_f32 v113, v113
  v_exp_f32 v114, v114
  v_exp_f32 v115, v115
  v_cvt_pk_bf16_f32 v138, v108, v109
  v_cvt_pk_bf16_f32 v139, v110, v111
  v_mfma_f32_32x32x16_bf16 v[56:71], v[180:183], v[148:151], v[56:71]
  buffer_load_dwordx4 v[168:171], v7, s[48:51], s6 offen sc1
  buffer_load_dwordx4 v[172:175], v7, s[48:51], s6 offen offset:1024 sc1
  s_add_u32 s6, s6, 4096
  v_exp_f32 v116, v116
  v_exp_f32 v117, v117
  v_exp_f32 v118, v118
  v_exp_f32 v119, v119
  v_cvt_pk_bf16_f32 v140, v112, v113
  v_cvt_pk_bf16_f32 v141, v114, v115
  v_cvt_pk_bf16_f32 v142, v116, v117
  v_cvt_pk_bf16_f32 v143, v118, v119
  s_waitcnt vmcnt(20)
  v_mfma_f32_32x32x16_bf16 v[104:119], v[184:187], v[8:11], 0
  v_exp_f32 v120, v120
  v_exp_f32 v121, v121
  v_exp_f32 v122, v122
  v_exp_f32 v123, v123
  v_mfma_f32_32x32x16_bf16 v[104:119], v[188:191], v[12:15], v[104:119]
  v_exp_f32 v124, v124
  v_exp_f32 v125, v125
  v_exp_f32 v126, v126
  v_exp_f32 v127, v127
  v_cvt_pk_bf16_f32 v144, v120, v121
  v_cvt_pk_bf16_f32 v145, v122, v123
  v_mfma_f32_32x32x16_bf16 v[72:87], v[176:179], v[136:139], v[72:87]
  v_exp_f32 v128, v128
  v_exp_f32 v129, v129
  v_exp_f32 v130, v130
  v_exp_f32 v131, v131
  v_cvt_pk_bf16_f32 v146, v124, v125
  v_cvt_pk_bf16_f32 v147, v126, v127
  v_mfma_f32_32x32x16_bf16 v[72:87], v[180:183], v[140:143], v[72:87]
  v_exp_f32 v132, v132
  v_exp_f32 v133, v133
  v_exp_f32 v134, v134
  v_exp_f32 v135, v135
  v_cvt_pk_bf16_f32 v148, v128, v129
  v_cvt_pk_bf16_f32 v149, v130, v131
  v_cvt_pk_bf16_f32 v150, v132, v133
  v_cvt_pk_bf16_f32 v151, v134, v135
  v_mfma_f32_32x32x16_bf16 v[120:135], v[184:187], v[16:19], 0
  v_exp_f32 v104, v104
  v_exp_f32 v105, v105
  v_exp_f32 v106, v106
  v_exp_f32 v107, v107
  v_mfma_f32_32x32x16_bf16 v[120:135], v[188:191], v[20:23], v[120:135]
  v_exp_f32 v108, v108
  v_exp_f32 v109, v109
  v_exp_f32 v110, v110
  v_exp_f32 v111, v111
  v_cvt_pk_bf16_f32 v136, v104, v105
  v_cvt_pk_bf16_f32 v137, v106, v107
  v_mfma_f32_32x32x16_bf16 v[88:103], v[176:179], v[144:147], v[88:103]
  v_exp_f32 v112, v112
  v_exp_f32 v113, v113
  v_exp_f32 v114, v114
  v_exp_f32 v115, v115
  v_cvt_pk_bf16_f32 v138, v108, v109
  v_cvt_pk_bf16_f32 v139, v110, v111
  v_mfma_f32_32x32x16_bf16 v[88:103], v[180:183], v[148:151], v[88:103]
  buffer_load_dwordx4 v[176:179], v7, s[48:51], s8 offen offset:2048 sc1
  buffer_load_dwordx4 v[180:183], v7, s[48:51], s8 offen offset:3072 sc1
  s_add_u32 s8, s8, 4096
  v_exp_f32 v116, v116
  v_exp_f32 v117, v117
  v_exp_f32 v118, v118
  v_exp_f32 v119, v119
  v_cvt_pk_bf16_f32 v140, v112, v113
  v_cvt_pk_bf16_f32 v141, v114, v115
  v_cvt_pk_bf16_f32 v142, v116, v117
  v_cvt_pk_bf16_f32 v143, v118, v119
  v_mfma_f32_32x32x16_bf16 v[104:119], v[184:187], v[24:27], 0
  v_exp_f32 v120, v120
  v_exp_f32 v121, v121
  v_exp_f32 v122, v122
  v_exp_f32 v123, v123
  v_mfma_f32_32x32x16_bf16 v[104:119], v[188:191], v[28:31], v[104:119]
  v_exp_f32 v124, v124
  v_exp_f32 v125, v125
  v_exp_f32 v126, v126
  v_exp_f32 v127, v127
  v_cvt_pk_bf16_f32 v144, v120, v121
  v_cvt_pk_bf16_f32 v145, v122, v123
  s_waitcnt vmcnt(20)
  v_mfma_f32_32x32x16_bf16 v[40:55], v[192:195], v[136:139], v[40:55]
  v_exp_f32 v128, v128
  v_exp_f32 v129, v129
  v_exp_f32 v130, v130
  v_exp_f32 v131, v131
  v_cvt_pk_bf16_f32 v146, v124, v125
  v_cvt_pk_bf16_f32 v147, v126, v127
  v_mfma_f32_32x32x16_bf16 v[40:55], v[196:199], v[140:143], v[40:55]
  v_exp_f32 v132, v132
  v_exp_f32 v133, v133
  v_exp_f32 v134, v134
  v_exp_f32 v135, v135
  v_cvt_pk_bf16_f32 v148, v128, v129
  v_cvt_pk_bf16_f32 v149, v130, v131
  v_cvt_pk_bf16_f32 v150, v132, v133
  v_cvt_pk_bf16_f32 v151, v134, v135
  v_mfma_f32_32x32x16_bf16 v[120:135], v[184:187], v[32:35], 0
  v_exp_f32 v104, v104
  v_exp_f32 v105, v105
  v_exp_f32 v106, v106
  v_exp_f32 v107, v107
  v_mfma_f32_32x32x16_bf16 v[120:135], v[188:191], v[36:39], v[120:135]
  v_exp_f32 v108, v108
  v_exp_f32 v109, v109
  v_exp_f32 v110, v110
  v_exp_f32 v111, v111
  v_cvt_pk_bf16_f32 v136, v104, v105
  v_cvt_pk_bf16_f32 v137, v106, v107
  v_mfma_f32_32x32x16_bf16 v[56:71], v[192:195], v[144:147], v[56:71]
  v_exp_f32 v112, v112
  v_exp_f32 v113, v113
  v_exp_f32 v114, v114
  v_exp_f32 v115, v115
  v_cvt_pk_bf16_f32 v138, v108, v109
  v_cvt_pk_bf16_f32 v139, v110, v111
  v_mfma_f32_32x32x16_bf16 v[56:71], v[196:199], v[148:151], v[56:71]
  buffer_load_dwordx4 v[184:187], v7, s[48:51], s6 offen sc1
  buffer_load_dwordx4 v[188:191], v7, s[48:51], s6 offen offset:1024 sc1
  s_add_u32 s6, s6, 4096
  v_exp_f32 v116, v116
  v_exp_f32 v117, v117
  v_exp_f32 v118, v118
  v_exp_f32 v119, v119
  v_cvt_pk_bf16_f32 v140, v112, v113
  v_cvt_pk_bf16_f32 v141, v114, v115
  v_cvt_pk_bf16_f32 v142, v116, v117
  v_cvt_pk_bf16_f32 v143, v118, v119
  s_waitcnt vmcnt(20)
  v_mfma_f32_32x32x16_bf16 v[104:119], v[200:203], v[8:11], 0
  v_exp_f32 v120, v120
  v_exp_f32 v121, v121
  v_exp_f32 v122, v122
  v_exp_f32 v123, v123
  v_mfma_f32_32x32x16_bf16 v[104:119], v[204:207], v[12:15], v[104:119]
  v_exp_f32 v124, v124
  v_exp_f32 v125, v125
  v_exp_f32 v126, v126
  v_exp_f32 v127, v127
  v_cvt_pk_bf16_f32 v144, v120, v121
  v_cvt_pk_bf16_f32 v145, v122, v123
  v_mfma_f32_32x32x16_bf16 v[72:87], v[192:195], v[136:139], v[72:87]
  v_exp_f32 v128, v128
  v_exp_f32 v129, v129
  v_exp_f32 v130, v130
  v_exp_f32 v131, v131
  v_cvt_pk_bf16_f32 v146, v124, v125
  v_cvt_pk_bf16_f32 v147, v126, v127
  v_mfma_f32_32x32x16_bf16 v[72:87], v[196:199], v[140:143], v[72:87]
  v_exp_f32 v132, v132
  v_exp_f32 v133, v133
  v_exp_f32 v134, v134
  v_exp_f32 v135, v135
  v_cvt_pk_bf16_f32 v148, v128, v129
  v_cvt_pk_bf16_f32 v149, v130, v131
  v_cvt_pk_bf16_f32 v150, v132, v133
  v_cvt_pk_bf16_f32 v151, v134, v135
  v_mfma_f32_32x32x16_bf16 v[120:135], v[200:203], v[16:19], 0
  v_exp_f32 v104, v104
  v_exp_f32 v105, v105
  v_exp_f32 v106, v106
  v_exp_f32 v107, v107
  v_mfma_f32_32x32x16_bf16 v[120:135], v[204:207], v[20:23], v[120:135]
  v_exp_f32 v108, v108
  v_exp_f32 v109, v109
  v_exp_f32 v110, v110
  v_exp_f32 v111, v111
  v_cvt_pk_bf16_f32 v136, v104, v105
  v_cvt_pk_bf16_f32 v137, v106, v107
  v_mfma_f32_32x32x16_bf16 v[88:103], v[192:195], v[144:147], v[88:103]
  v_exp_f32 v112, v112
  v_exp_f32 v113, v113
  v_exp_f32 v114, v114
  v_exp_f32 v115, v115
  v_cvt_pk_bf16_f32 v138, v108, v109
  v_cvt_pk_bf16_f32 v139, v110, v111
  v_mfma_f32_32x32x16_bf16 v[88:103], v[196:199], v[148:151], v[88:103]
  buffer_load_dwordx4 v[192:195], v7, s[48:51], s8 offen offset:2048 sc1
  buffer_load_dwordx4 v[196:199], v7, s[48:51], s8 offen offset:3072 sc1
  s_add_u32 s8, s8, 4096
  v_exp_f32 v116, v116
  v_exp_f32 v117, v117
  v_exp_f32 v118, v118
  v_exp_f32 v119, v119
  v_cvt_pk_bf16_f32 v140, v112, v113
  v_cvt_pk_bf16_f32 v141, v114, v115
  v_cvt_pk_bf16_f32 v142, v116, v117
  v_cvt_pk_bf16_f32 v143, v118, v119
  v_mfma_f32_32x32x16_bf16 v[104:119], v[200:203], v[24:27], 0
  v_exp_f32 v120, v120
  v_exp_f32 v121, v121
  v_exp_f32 v122, v122
  v_exp_f32 v123, v123
  v_mfma_f32_32x32x16_bf16 v[104:119], v[204:207], v[28:31], v[104:119]
  v_exp_f32 v124, v124
  v_exp_f32 v125, v125
  v_exp_f32 v126, v126
  v_exp_f32 v127, v127
  v_cvt_pk_bf16_f32 v144, v120, v121
  v_cvt_pk_bf16_f32 v145, v122, v123
  s_waitcnt vmcnt(20)
  v_mfma_f32_32x32x16_bf16 v[40:55], v[208:211], v[136:139], v[40:55]
  v_exp_f32 v128, v128
  v_exp_f32 v129, v129
  v_exp_f32 v130, v130
  v_exp_f32 v131, v131
  v_cvt_pk_bf16_f32 v146, v124, v125
  v_cvt_pk_bf16_f32 v147, v126, v127
  v_mfma_f32_32x32x16_bf16 v[40:55], v[212:215], v[140:143], v[40:55]
  v_exp_f32 v132, v132
  v_exp_f32 v133, v133
  v_exp_f32 v134, v134
  v_exp_f32 v135, v135
  v_cvt_pk_bf16_f32 v148, v128, v129
  v_cvt_pk_bf16_f32 v149, v130, v131
  v_cvt_pk_bf16_f32 v150, v132, v133
  v_cvt_pk_bf16_f32 v151, v134, v135
  v_mfma_f32_32x32x16_bf16 v[120:135], v[200:203], v[32:35], 0
  v_exp_f32 v104, v104
  v_exp_f32 v105, v105
  v_exp_f32 v106, v106
  v_exp_f32 v107, v107
  v_mfma_f32_32x32x16_bf16 v[120:135], v[204:207], v[36:39], v[120:135]
  v_exp_f32 v108, v108
  v_exp_f32 v109, v109
  v_exp_f32 v110, v110
  v_exp_f32 v111, v111
  v_cvt_pk_bf16_f32 v136, v104, v105
  v_cvt_pk_bf16_f32 v137, v106, v107
  v_mfma_f32_32x32x16_bf16 v[56:71], v[208:211], v[144:147], v[56:71]
  v_exp_f32 v112, v112
  v_exp_f32 v113, v113
  v_exp_f32 v114, v114
  v_exp_f32 v115, v115
  v_cvt_pk_bf16_f32 v138, v108, v109
  v_cvt_pk_bf16_f32 v139, v110, v111
  v_mfma_f32_32x32x16_bf16 v[56:71], v[212:215], v[148:151], v[56:71]
  buffer_load_dwordx4 v[200:203], v7, s[48:51], s6 offen sc1
  buffer_load_dwordx4 v[204:207], v7, s[48:51], s6 offen offset:1024 sc1
  s_add_u32 s6, s6, 4096
  v_exp_f32 v116, v116
  v_exp_f32 v117, v117
  v_exp_f32 v118, v118
  v_exp_f32 v119, v119
  v_cvt_pk_bf16_f32 v140, v112, v113
  v_cvt_pk_bf16_f32 v141, v114, v115
  v_cvt_pk_bf16_f32 v142, v116, v117
  v_cvt_pk_bf16_f32 v143, v118, v119
  s_waitcnt vmcnt(20)
  v_mfma_f32_32x32x16_bf16 v[104:119], v[216:219], v[8:11], 0
  v_exp_f32 v120, v120
  v_exp_f32 v121, v121
  v_exp_f32 v122, v122
  v_exp_f32 v123, v123
  v_mfma_f32_32x32x16_bf16 v[104:119], v[220:223], v[12:15], v[104:119]
  v_exp_f32 v124, v124
  v_exp_f32 v125, v125
  v_exp_f32 v126, v126
  v_exp_f32 v127, v127
  v_cvt_pk_bf16_f32 v144, v120, v121
  v_cvt_pk_bf16_f32 v145, v122, v123
  v_mfma_f32_32x32x16_bf16 v[72:87], v[208:211], v[136:139], v[72:87]
  v_exp_f32 v128, v128
  v_exp_f32 v129, v129
  v_exp_f32 v130, v130
  v_exp_f32 v131, v131
  v_cvt_pk_bf16_f32 v146, v124, v125
  v_cvt_pk_bf16_f32 v147, v126, v127
  v_mfma_f32_32x32x16_bf16 v[72:87], v[212:215], v[140:143], v[72:87]
  v_exp_f32 v132, v132
  v_exp_f32 v133, v133
  v_exp_f32 v134, v134
  v_exp_f32 v135, v135
  v_cvt_pk_bf16_f32 v148, v128, v129
  v_cvt_pk_bf16_f32 v149, v130, v131
  v_cvt_pk_bf16_f32 v150, v132, v133
  v_cvt_pk_bf16_f32 v151, v134, v135
  ds_write_b32 v248, v249
  v_mfma_f32_32x32x16_bf16 v[120:135], v[216:219], v[16:19], 0
  v_exp_f32 v104, v104
  v_exp_f32 v105, v105
  v_exp_f32 v106, v106
  v_exp_f32 v107, v107
  v_mfma_f32_32x32x16_bf16 v[120:135], v[220:223], v[20:23], v[120:135]
  v_exp_f32 v108, v108
  v_exp_f32 v109, v109
  v_exp_f32 v110, v110
  v_exp_f32 v111, v111
  v_cvt_pk_bf16_f32 v136, v104, v105
  v_cvt_pk_bf16_f32 v137, v106, v107
  v_mfma_f32_32x32x16_bf16 v[88:103], v[208:211], v[144:147], v[88:103]
  v_exp_f32 v112, v112
  v_exp_f32 v113, v113
  v_exp_f32 v114, v114
  v_exp_f32 v115, v115
  v_cvt_pk_bf16_f32 v138, v108, v109
  v_cvt_pk_bf16_f32 v139, v110, v111
  v_mfma_f32_32x32x16_bf16 v[88:103], v[212:215], v[148:151], v[88:103]
  buffer_load_dwordx4 v[208:211], v7, s[48:51], s8 offen offset:2048 sc1
  buffer_load_dwordx4 v[212:215], v7, s[48:51], s8 offen offset:3072 sc1
  s_add_u32 s8, s8, 4096
  v_exp_f32 v116, v116
  v_exp_f32 v117, v117
  v_exp_f32 v118, v118
  v_exp_f32 v119, v119
  v_cvt_pk_bf16_f32 v140, v112, v113
  v_cvt_pk_bf16_f32 v141, v114, v115
  v_cvt_pk_bf16_f32 v142, v116, v117
  v_cvt_pk_bf16_f32 v143, v118, v119
  v_mfma_f32_32x32x16_bf16 v[104:119], v[216:219], v[24:27], 0
  v_exp_f32 v120, v120
  v_exp_f32 v121, v121
  v_exp_f32 v122, v122
  v_exp_f32 v123, v123
  v_mfma_f32_32x32x16_bf16 v[104:119], v[220:223], v[28:31], v[104:119]
  v_exp_f32 v124, v124
  v_exp_f32 v125, v125
  v_exp_f32 v126, v126
  v_exp_f32 v127, v127
  v_cvt_pk_bf16_f32 v144, v120, v121
  v_cvt_pk_bf16_f32 v145, v122, v123
  s_waitcnt vmcnt(20)
  v_mfma_f32_32x32x16_bf16 v[40:55], v[224:227], v[136:139], v[40:55]
  v_exp_f32 v128, v128
  v_exp_f32 v129, v129
  v_exp_f32 v130, v130
  v_exp_f32 v131, v131
  v_cvt_pk_bf16_f32 v146, v124, v125
  v_cvt_pk_bf16_f32 v147, v126, v127
  v_mfma_f32_32x32x16_bf16 v[40:55], v[228:231], v[140:143], v[40:55]
  v_exp_f32 v132, v132
  v_exp_f32 v133, v133
  v_exp_f32 v134, v134
  v_exp_f32 v135, v135
  v_cvt_pk_bf16_f32 v148, v128, v129
  v_cvt_pk_bf16_f32 v149, v130, v131
  v_cvt_pk_bf16_f32 v150, v132, v133
  v_cvt_pk_bf16_f32 v151, v134, v135
  v_mfma_f32_32x32x16_bf16 v[120:135], v[216:219], v[32:35], 0
  v_exp_f32 v104, v104
  v_exp_f32 v105, v105
  v_exp_f32 v106, v106
  v_exp_f32 v107, v107
  v_mfma_f32_32x32x16_bf16 v[120:135], v[220:223], v[36:39], v[120:135]
  v_exp_f32 v108, v108
  v_exp_f32 v109, v109
  v_exp_f32 v110, v110
  v_exp_f32 v111, v111
  v_cvt_pk_bf16_f32 v136, v104, v105
  v_cvt_pk_bf16_f32 v137, v106, v107
  v_mfma_f32_32x32x16_bf16 v[56:71], v[224:227], v[144:147], v[56:71]
  v_exp_f32 v112, v112
  v_exp_f32 v113, v113
  v_exp_f32 v114, v114
  v_exp_f32 v115, v115
  v_cvt_pk_bf16_f32 v138, v108, v109
  v_cvt_pk_bf16_f32 v139, v110, v111
  v_mfma_f32_32x32x16_bf16 v[56:71], v[228:231], v[148:151], v[56:71]
  v_exp_f32 v116, v116
  v_exp_f32 v117, v117
  v_exp_f32 v118, v118
  v_exp_f32 v119, v119
  v_cvt_pk_bf16_f32 v140, v112, v113
  v_cvt_pk_bf16_f32 v141, v114, v115
  v_cvt_pk_bf16_f32 v142, v116, v117
  v_cvt_pk_bf16_f32 v143, v118, v119
  s_waitcnt vmcnt(18)
  v_mfma_f32_32x32x16_bf16 v[104:119], v[232:235], v[8:11], 0
  v_exp_f32 v120, v120
  v_exp_f32 v121, v121
  v_exp_f32 v122, v122
  v_exp_f32 v123, v123
  v_mfma_f32_32x32x16_bf16 v[104:119], v[236:239], v[12:15], v[104:119]
  v_exp_f32 v124, v124
  v_exp_f32 v125, v125
  v_exp_f32 v126, v126
  v_exp_f32 v127, v127
  v_cvt_pk_bf16_f32 v144, v120, v121
  v_cvt_pk_bf16_f32 v145, v122, v123
  v_mfma_f32_32x32x16_bf16 v[72:87], v[224:227], v[136:139], v[72:87]
  v_exp_f32 v128, v128
  v_exp_f32 v129, v129
  v_exp_f32 v130, v130
  v_exp_f32 v131, v131
  v_cvt_pk_bf16_f32 v146, v124, v125
  v_cvt_pk_bf16_f32 v147, v126, v127
  v_mfma_f32_32x32x16_bf16 v[72:87], v[228:231], v[140:143], v[72:87]
  v_exp_f32 v132, v132
  v_exp_f32 v133, v133
  v_exp_f32 v134, v134
  v_exp_f32 v135, v135
  v_cvt_pk_bf16_f32 v148, v128, v129
  v_cvt_pk_bf16_f32 v149, v130, v131
  v_cvt_pk_bf16_f32 v150, v132, v133
  v_cvt_pk_bf16_f32 v151, v134, v135
  v_mfma_f32_32x32x16_bf16 v[120:135], v[232:235], v[16:19], 0
  v_exp_f32 v104, v104
  v_exp_f32 v105, v105
  v_exp_f32 v106, v106
  v_exp_f32 v107, v107
  v_mfma_f32_32x32x16_bf16 v[120:135], v[236:239], v[20:23], v[120:135]
  v_exp_f32 v108, v108
  v_exp_f32 v109, v109
  v_exp_f32 v110, v110
  v_exp_f32 v111, v111
  v_cvt_pk_bf16_f32 v136, v104, v105
  v_cvt_pk_bf16_f32 v137, v106, v107
  v_mfma_f32_32x32x16_bf16 v[88:103], v[224:227], v[144:147], v[88:103]
  v_exp_f32 v112, v112
  v_exp_f32 v113, v113
  v_exp_f32 v114, v114
  v_exp_f32 v115, v115
  v_cvt_pk_bf16_f32 v138, v108, v109
  v_cvt_pk_bf16_f32 v139, v110, v111
  v_mfma_f32_32x32x16_bf16 v[88:103], v[228:231], v[148:151], v[88:103]
  v_exp_f32 v116, v116
  v_exp_f32 v117, v117
  v_exp_f32 v118, v118
  v_exp_f32 v119, v119
  v_cvt_pk_bf16_f32 v140, v112, v113
  v_cvt_pk_bf16_f32 v141, v114, v115
  v_cvt_pk_bf16_f32 v142, v116, v117
  v_cvt_pk_bf16_f32 v143, v118, v119
  v_mfma_f32_32x32x16_bf16 v[104:119], v[232:235], v[24:27], 0
  v_exp_f32 v120, v120
  v_exp_f32 v121, v121
  v_exp_f32 v122, v122
  v_exp_f32 v123, v123
  v_mfma_f32_32x32x16_bf16 v[104:119], v[236:239], v[28:31], v[104:119]
  v_exp_f32 v124, v124
  v_exp_f32 v125, v125
  v_exp_f32 v126, v126
  v_exp_f32 v127, v127
  v_cvt_pk_bf16_f32 v144, v120, v121
  v_cvt_pk_bf16_f32 v145, v122, v123
  s_waitcnt vmcnt(16)
  v_mfma_f32_32x32x16_bf16 v[40:55], v[240:243], v[136:139], v[40:55]
  v_exp_f32 v128, v128
  v_exp_f32 v129, v129
  v_exp_f32 v130, v130
  v_exp_f32 v131, v131
  v_cvt_pk_bf16_f32 v146, v124, v125
  v_cvt_pk_bf16_f32 v147, v126, v127
  v_mfma_f32_32x32x16_bf16 v[40:55], v[244:247], v[140:143], v[40:55]
  v_exp_f32 v132, v132
  v_exp_f32 v133, v133
  v_exp_f32 v134, v134
  v_exp_f32 v135, v135
  v_cvt_pk_bf16_f32 v148, v128, v129
  v_cvt_pk_bf16_f32 v149, v130, v131
  v_cvt_pk_bf16_f32 v150, v132, v133
  v_cvt_pk_bf16_f32 v151, v134, v135
  v_mfma_f32_32x32x16_bf16 v[120:135], v[232:235], v[32:35], 0
  v_exp_f32 v104, v104
  v_exp_f32 v105, v105
  v_exp_f32 v106, v106
  v_exp_f32 v107, v107
  v_mfma_f32_32x32x16_bf16 v[120:135], v[236:239], v[36:39], v[120:135]
  v_exp_f32 v108, v108
  v_exp_f32 v109, v109
  v_exp_f32 v110, v110
  v_exp_f32 v111, v111
  v_cvt_pk_bf16_f32 v136, v104, v105
  v_cvt_pk_bf16_f32 v137, v106, v107
  v_mfma_f32_32x32x16_bf16 v[56:71], v[240:243], v[144:147], v[56:71]
  v_exp_f32 v112, v112
  v_exp_f32 v113, v113
  v_exp_f32 v114, v114
  v_exp_f32 v115, v115
  v_cvt_pk_bf16_f32 v138, v108, v109
  v_cvt_pk_bf16_f32 v139, v110, v111
  v_mfma_f32_32x32x16_bf16 v[56:71], v[244:247], v[148:151], v[56:71]
  v_exp_f32 v116, v116
  v_exp_f32 v117, v117
  v_exp_f32 v118, v118
  v_exp_f32 v119, v119
  v_cvt_pk_bf16_f32 v140, v112, v113
  v_cvt_pk_bf16_f32 v141, v114, v115
  v_cvt_pk_bf16_f32 v142, v116, v117
  v_cvt_pk_bf16_f32 v143, v118, v119
  s_waitcnt vmcnt(14)
  v_mfma_f32_32x32x16_bf16 v[104:119], v[152:155], v[8:11], 0
  v_exp_f32 v120, v120
  v_exp_f32 v121, v121
  v_exp_f32 v122, v122
  v_exp_f32 v123, v123
  v_mfma_f32_32x32x16_bf16 v[104:119], v[156:159], v[12:15], v[104:119]
  v_exp_f32 v124, v124
  v_exp_f32 v125, v125
  v_exp_f32 v126, v126
  v_exp_f32 v127, v127
  v_cvt_pk_bf16_f32 v144, v120, v121
  v_cvt_pk_bf16_f32 v145, v122, v123
  v_mfma_f32_32x32x16_bf16 v[72:87], v[240:243], v[136:139], v[72:87]
  v_exp_f32 v128, v128
  v_exp_f32 v129, v129
  v_exp_f32 v130, v130
  v_exp_f32 v131, v131
  v_cvt_pk_bf16_f32 v146, v124, v125
  v_cvt_pk_bf16_f32 v147, v126, v127
  v_mfma_f32_32x32x16_bf16 v[72:87], v[244:247], v[140:143], v[72:87]
  v_exp_f32 v132, v132
  v_exp_f32 v133, v133
  v_exp_f32 v134, v134
  v_exp_f32 v135, v135
  v_cvt_pk_bf16_f32 v148, v128, v129
  v_cvt_pk_bf16_f32 v149, v130, v131
  v_cvt_pk_bf16_f32 v150, v132, v133
  v_cvt_pk_bf16_f32 v151, v134, v135
  v_mfma_f32_32x32x16_bf16 v[120:135], v[152:155], v[16:19], 0
  v_exp_f32 v104, v104
  v_exp_f32 v105, v105
  v_exp_f32 v106, v106
  v_exp_f32 v107, v107
  v_mfma_f32_32x32x16_bf16 v[120:135], v[156:159], v[20:23], v[120:135]
  v_exp_f32 v108, v108
  v_exp_f32 v109, v109
  v_exp_f32 v110, v110
  v_exp_f32 v111, v111
  v_cvt_pk_bf16_f32 v136, v104, v105
  v_cvt_pk_bf16_f32 v137, v106, v107
  v_mfma_f32_32x32x16_bf16 v[88:103], v[240:243], v[144:147], v[88:103]
  v_exp_f32 v112, v112
  v_exp_f32 v113, v113
  v_exp_f32 v114, v114
  v_exp_f32 v115, v115
  v_cvt_pk_bf16_f32 v138, v108, v109
  v_cvt_pk_bf16_f32 v139, v110, v111
  v_mfma_f32_32x32x16_bf16 v[88:103], v[244:247], v[148:151], v[88:103]
  v_exp_f32 v116, v116
  v_exp_f32 v117, v117
  v_exp_f32 v118, v118
  v_exp_f32 v119, v119
  v_cvt_pk_bf16_f32 v140, v112, v113
  v_cvt_pk_bf16_f32 v141, v114, v115
  v_cvt_pk_bf16_f32 v142, v116, v117
  v_cvt_pk_bf16_f32 v143, v118, v119
  v_mfma_f32_32x32x16_bf16 v[104:119], v[152:155], v[24:27], 0
  v_exp_f32 v120, v120
  v_exp_f32 v121, v121
  v_exp_f32 v122, v122
  v_exp_f32 v123, v123
  v_mfma_f32_32x32x16_bf16 v[104:119], v[156:159], v[28:31], v[104:119]
  v_exp_f32 v124, v124
  v_exp_f32 v125, v125
  v_exp_f32 v126, v126
  v_exp_f32 v127, v127
  v_cvt_pk_bf16_f32 v144, v120, v121
  v_cvt_pk_bf16_f32 v145, v122, v123
  s_waitcnt vmcnt(12)
  v_mfma_f32_32x32x16_bf16 v[40:55], v[160:163], v[136:139], v[40:55]
  v_exp_f32 v128, v128
  v_exp_f32 v129, v129
  v_exp_f32 v130, v130
  v_exp_f32 v131, v131
  v_cvt_pk_bf16_f32 v146, v124, v125
  v_cvt_pk_bf16_f32 v147, v126, v127
  v_mfma_f32_32x32x16_bf16 v[40:55], v[164:167], v[140:143], v[40:55]
  v_exp_f32 v132, v132
  v_exp_f32 v133, v133
  v_exp_f32 v134, v134
  v_exp_f32 v135, v135
  v_cvt_pk_bf16_f32 v148, v128, v129
  v_cvt_pk_bf16_f32 v149, v130, v131
  v_cvt_pk_bf16_f32 v150, v132, v133
  v_cvt_pk_bf16_f32 v151, v134, v135
  v_mfma_f32_32x32x16_bf16 v[120:135], v[152:155], v[32:35], 0
  v_exp_f32 v104, v104
  v_exp_f32 v105, v105
  v_exp_f32 v106, v106
  v_exp_f32 v107, v107
  v_mfma_f32_32x32x16_bf16 v[120:135], v[156:159], v[36:39], v[120:135]
  v_exp_f32 v108, v108
  v_exp_f32 v109, v109
  v_exp_f32 v110, v110
  v_exp_f32 v111, v111
  v_cvt_pk_bf16_f32 v136, v104, v105
  v_cvt_pk_bf16_f32 v137, v106, v107
  v_mfma_f32_32x32x16_bf16 v[56:71], v[160:163], v[144:147], v[56:71]
  v_exp_f32 v112, v112
  v_exp_f32 v113, v113
  v_exp_f32 v114, v114
  v_exp_f32 v115, v115
  v_cvt_pk_bf16_f32 v138, v108, v109
  v_cvt_pk_bf16_f32 v139, v110, v111
  v_mfma_f32_32x32x16_bf16 v[56:71], v[164:167], v[148:151], v[56:71]
  v_exp_f32 v116, v116
  v_exp_f32 v117, v117
  v_exp_f32 v118, v118
  v_exp_f32 v119, v119
  v_cvt_pk_bf16_f32 v140, v112, v113
  v_cvt_pk_bf16_f32 v141, v114, v115
  v_cvt_pk_bf16_f32 v142, v116, v117
  v_cvt_pk_bf16_f32 v143, v118, v119
  s_waitcnt vmcnt(10)
  v_mfma_f32_32x32x16_bf16 v[104:119], v[168:171], v[8:11], 0
  v_exp_f32 v120, v120
  v_exp_f32 v121, v121
  v_exp_f32 v122, v122
  v_exp_f32 v123, v123
  v_mfma_f32_32x32x16_bf16 v[104:119], v[172:175], v[12:15], v[104:119]
  v_exp_f32 v124, v124
  v_exp_f32 v125, v125
  v_exp_f32 v126, v126
  v_exp_f32 v127, v127
  v_cvt_pk_bf16_f32 v144, v120, v121
  v_cvt_pk_bf16_f32 v145, v122, v123
  v_mfma_f32_32x32x16_bf16 v[72:87], v[160:163], v[136:139], v[72:87]
  v_exp_f32 v128, v128
  v_exp_f32 v129, v129
  v_exp_f32 v130, v130
  v_exp_f32 v131, v131
  v_cvt_pk_bf16_f32 v146, v124, v125
  v_cvt_pk_bf16_f32 v147, v126, v127
  v_mfma_f32_32x32x16_bf16 v[72:87], v[164:167], v[140:143], v[72:87]
  v_exp_f32 v132, v132
  v_exp_f32 v133, v133
  v_exp_f32 v134, v134
  v_exp_f32 v135, v135
  v_cvt_pk_bf16_f32 v148, v128, v129
  v_cvt_pk_bf16_f32 v149, v130, v131
  v_cvt_pk_bf16_f32 v150, v132, v133
  v_cvt_pk_bf16_f32 v151, v134, v135
  v_mfma_f32_32x32x16_bf16 v[120:135], v[168:171], v[16:19], 0
  v_exp_f32 v104, v104
  v_exp_f32 v105, v105
  v_exp_f32 v106, v106
  v_exp_f32 v107, v107
  v_mfma_f32_32x32x16_bf16 v[120:135], v[172:175], v[20:23], v[120:135]
  v_exp_f32 v108, v108
  v_exp_f32 v109, v109
  v_exp_f32 v110, v110
  v_exp_f32 v111, v111
  v_cvt_pk_bf16_f32 v136, v104, v105
  v_cvt_pk_bf16_f32 v137, v106, v107
  v_mfma_f32_32x32x16_bf16 v[88:103], v[160:163], v[144:147], v[88:103]
  v_exp_f32 v112, v112
  v_exp_f32 v113, v113
  v_exp_f32 v114, v114
  v_exp_f32 v115, v115
  v_cvt_pk_bf16_f32 v138, v108, v109
  v_cvt_pk_bf16_f32 v139, v110, v111
  v_mfma_f32_32x32x16_bf16 v[88:103], v[164:167], v[148:151], v[88:103]
  v_exp_f32 v116, v116
  v_exp_f32 v117, v117
  v_exp_f32 v118, v118
  v_exp_f32 v119, v119
  v_cvt_pk_bf16_f32 v140, v112, v113
  v_cvt_pk_bf16_f32 v141, v114, v115
  v_cvt_pk_bf16_f32 v142, v116, v117
  v_cvt_pk_bf16_f32 v143, v118, v119
  v_mfma_f32_32x32x16_bf16 v[104:119], v[168:171], v[24:27], 0
  v_exp_f32 v120, v120
  v_exp_f32 v121, v121
  v_exp_f32 v122, v122
  v_exp_f32 v123, v123
  v_mfma_f32_32x32x16_bf16 v[104:119], v[172:175], v[28:31], v[104:119]
  v_exp_f32 v124, v124
  v_exp_f32 v125, v125
  v_exp_f32 v126, v126
  v_exp_f32 v127, v127
  v_cvt_pk_bf16_f32 v144, v120, v121
  v_cvt_pk_bf16_f32 v145, v122, v123
  s_waitcnt vmcnt(8)
  v_mfma_f32_32x32x16_bf16 v[40:55], v[176:179], v[136:139], v[40:55]
  v_exp_f32 v128, v128
  v_exp_f32 v129, v129
  v_exp_f32 v130, v130
  v_exp_f32 v131, v131
  v_cvt_pk_bf16_f32 v146, v124, v125
  v_cvt_pk_bf16_f32 v147, v126, v127
  v_mfma_f32_32x32x16_bf16 v[40:55], v[180:183], v[140:143], v[40:55]
  v_exp_f32 v132, v132
  v_exp_f32 v133, v133
  v_exp_f32 v134, v134
  v_exp_f32 v135, v135
  v_cvt_pk_bf16_f32 v148, v128, v129
  v_cvt_pk_bf16_f32 v149, v130, v131
  v_cvt_pk_bf16_f32 v150, v132, v133
  v_cvt_pk_bf16_f32 v151, v134, v135
  v_mfma_f32_32x32x16_bf16 v[120:135], v[168:171], v[32:35], 0
  v_exp_f32 v104, v104
  v_exp_f32 v105, v105
  v_exp_f32 v106, v106
  v_exp_f32 v107, v107
  v_mfma_f32_32x32x16_bf16 v[120:135], v[172:175], v[36:39], v[120:135]
  v_exp_f32 v108, v108
  v_exp_f32 v109, v109
  v_exp_f32 v110, v110
  v_exp_f32 v111, v111
  v_cvt_pk_bf16_f32 v136, v104, v105
  v_cvt_pk_bf16_f32 v137, v106, v107
  v_mfma_f32_32x32x16_bf16 v[56:71], v[176:179], v[144:147], v[56:71]
  v_exp_f32 v112, v112
  v_exp_f32 v113, v113
  v_exp_f32 v114, v114
  v_exp_f32 v115, v115
  v_cvt_pk_bf16_f32 v138, v108, v109
  v_cvt_pk_bf16_f32 v139, v110, v111
  v_mfma_f32_32x32x16_bf16 v[56:71], v[180:183], v[148:151], v[56:71]
  v_exp_f32 v116, v116
  v_exp_f32 v117, v117
  v_exp_f32 v118, v118
  v_exp_f32 v119, v119
  v_cvt_pk_bf16_f32 v140, v112, v113
  v_cvt_pk_bf16_f32 v141, v114, v115
  v_cvt_pk_bf16_f32 v142, v116, v117
  v_cvt_pk_bf16_f32 v143, v118, v119
  s_waitcnt vmcnt(6)
  v_mfma_f32_32x32x16_bf16 v[104:119], v[184:187], v[8:11], 0
  v_exp_f32 v120, v120
  v_exp_f32 v121, v121
  v_exp_f32 v122, v122
  v_exp_f32 v123, v123
  v_mfma_f32_32x32x16_bf16 v[104:119], v[188:191], v[12:15], v[104:119]
  v_exp_f32 v124, v124
  v_exp_f32 v125, v125
  v_exp_f32 v126, v126
  v_exp_f32 v127, v127
  v_cvt_pk_bf16_f32 v144, v120, v121
  v_cvt_pk_bf16_f32 v145, v122, v123
  v_mfma_f32_32x32x16_bf16 v[72:87], v[176:179], v[136:139], v[72:87]
  v_exp_f32 v128, v128
  v_exp_f32 v129, v129
  v_exp_f32 v130, v130
  v_exp_f32 v131, v131
  v_cvt_pk_bf16_f32 v146, v124, v125
  v_cvt_pk_bf16_f32 v147, v126, v127
  v_mfma_f32_32x32x16_bf16 v[72:87], v[180:183], v[140:143], v[72:87]
  v_exp_f32 v132, v132
  v_exp_f32 v133, v133
  v_exp_f32 v134, v134
  v_exp_f32 v135, v135
  v_cvt_pk_bf16_f32 v148, v128, v129
  v_cvt_pk_bf16_f32 v149, v130, v131
  v_cvt_pk_bf16_f32 v150, v132, v133
  v_cvt_pk_bf16_f32 v151, v134, v135
  v_mfma_f32_32x32x16_bf16 v[120:135], v[184:187], v[16:19], 0
  v_exp_f32 v104, v104
  v_exp_f32 v105, v105
  v_exp_f32 v106, v106
  v_exp_f32 v107, v107
  v_mfma_f32_32x32x16_bf16 v[120:135], v[188:191], v[20:23], v[120:135]
  v_exp_f32 v108, v108
  v_exp_f32 v109, v109
  v_exp_f32 v110, v110
  v_exp_f32 v111, v111
  v_cvt_pk_bf16_f32 v136, v104, v105
  v_cvt_pk_bf16_f32 v137, v106, v107
  v_mfma_f32_32x32x16_bf16 v[88:103], v[176:179], v[144:147], v[88:103]
  v_exp_f32 v112, v112
  v_exp_f32 v113, v113
  v_exp_f32 v114, v114
  v_exp_f32 v115, v115
  v_cvt_pk_bf16_f32 v138, v108, v109
  v_cvt_pk_bf16_f32 v139, v110, v111
  v_mfma_f32_32x32x16_bf16 v[88:103], v[180:183], v[148:151], v[88:103]
  v_exp_f32 v116, v116
  v_exp_f32 v117, v117
  v_exp_f32 v118, v118
  v_exp_f32 v119, v119
  v_cvt_pk_bf16_f32 v140, v112, v113
  v_cvt_pk_bf16_f32 v141, v114, v115
  v_cvt_pk_bf16_f32 v142, v116, v117
  v_cvt_pk_bf16_f32 v143, v118, v119
  v_mov_b32 v4, 36864
  s_mov_b32 s14, 0
lw_23:
  ds_read_b32 v5, v4
  s_add_u32 s14, s14, 1
  s_waitcnt lgkmcnt(0)
  v_readfirstlane_b32 s15, v5
  s_cmp_gt_u32 s14, 0x200000
  s_cbranch_scc1 lwe_24
  s_cmp_ge_u32 s15, 4
  s_cbranch_scc1 lwe_24
  s_branch lw_23
lwe_24:
  v_mov_b32 v4, 36928
  s_mov_b32 s14, 0
lw_25:
  ds_read_b32 v5, v4
  s_add_u32 s14, s14, 1
  s_waitcnt lgkmcnt(0)
  v_readfirstlane_b32 s15, v5
  s_cmp_gt_u32 s14, 0x200000
  s_cbranch_scc1 lwe_26
  s_cmp_ge_u32 s15, 1
  s_cbranch_scc1 lwe_26
  s_branch lw_25
lwe_26:
  v_mov_b32 v4, 36932
  s_mov_b32 s14, 0
lw_27:
  ds_read_b32 v5, v4
  s_add_u32 s14, s14, 1
  s_waitcnt lgkmcnt(0)
  v_readfirstlane_b32 s15, v5
  s_cmp_gt_u32 s14, 0x200000
  s_cbranch_scc1 lwe_28
  s_cmp_ge_u32 s15, 1
  s_cbranch_scc1 lwe_28
  s_branch lw_27
lwe_28:
  v_mov_b32 v4, 36936
  s_mov_b32 s14, 0
lw_29:
  ds_read_b32 v5, v4
  s_add_u32 s14, s14, 1
  s_waitcnt lgkmcnt(0)
  v_readfirstlane_b32 s15, v5
  s_cmp_gt_u32 s14, 0x200000
  s_cbranch_scc1 lwe_30
  s_cmp_ge_u32 s15, 1
  s_cbranch_scc1 lwe_30
  s_branch lw_29
lwe_30:
  v_mov_b32 v4, 36940
  s_mov_b32 s14, 0
lw_31:
  ds_read_b32 v5, v4
  s_add_u32 s14, s14, 1
  s_waitcnt lgkmcnt(0)
  v_readfirstlane_b32 s15, v5
  s_cmp_gt_u32 s14, 0x200000
  s_cbranch_scc1 lwe_32
  s_cmp_ge_u32 s15, 1
  s_cbranch_scc1 lwe_32
  s_branch lw_31
lwe_32:
  v_mfma_f32_32x32x16_bf16 v[104:119], v[184:187], v[24:27], 0
  v_exp_f32 v120, v120
  v_exp_f32 v121, v121
  v_exp_f32 v122, v122
  v_exp_f32 v123, v123
  v_mfma_f32_32x32x16_bf16 v[104:119], v[188:191], v[28:31], v[104:119]
  v_exp_f32 v124, v124
  v_exp_f32 v125, v125
  v_exp_f32 v126, v126
  v_exp_f32 v127, v127
  v_cvt_pk_bf16_f32 v144, v120, v121
  v_cvt_pk_bf16_f32 v145, v122, v123
  s_waitcnt vmcnt(4)
  v_mfma_f32_32x32x16_bf16 v[40:55], v[192:195], v[136:139], v[40:55]
  v_exp_f32 v128, v128
  v_exp_f32 v129, v129
  v_exp_f32 v130, v130
  v_exp_f32 v131, v131
  v_cvt_pk_bf16_f32 v146, v124, v125
  v_cvt_pk_bf16_f32 v147, v126, v127
  v_mfma_f32_32x32x16_bf16 v[40:55], v[196:199], v[140:143], v[40:55]
  v_exp_f32 v132, v132
  v_exp_f32 v133, v133
  v_exp_f32 v134, v134
  v_exp_f32 v135, v135
  v_cvt_pk_bf16_f32 v148, v128, v129
  v_cvt_pk_bf16_f32 v149, v130, v131
  v_cvt_pk_bf16_f32 v150, v132, v133
  v_cvt_pk_bf16_f32 v151, v134, v135
  v_mfma_f32_32x32x16_bf16 v[120:135], v[184:187], v[32:35], 0
  v_exp_f32 v104, v104
  v_exp_f32 v105, v105
  v_exp_f32 v106, v106
  v_exp_f32 v107, v107
  v_mfma_f32_32x32x16_bf16 v[120:135], v[188:191], v[36:39], v[120:135]
  v_exp_f32 v108, v108
  v_exp_f32 v109, v109
  v_exp_f32 v110, v110
  v_exp_f32 v111, v111
  v_cvt_pk_bf16_f32 v136, v104, v105
  v_cvt_pk_bf16_f32 v137, v106, v107
  v_mfma_f32_32x32x16_bf16 v[56:71], v[192:195], v[144:147], v[56:71]
  v_exp_f32 v112, v112
  v_exp_f32 v113, v113
  v_exp_f32 v114, v114
  v_exp_f32 v115, v115
  v_cvt_pk_bf16_f32 v138, v108, v109
  v_cvt_pk_bf16_f32 v139, v110, v111
  v_mfma_f32_32x32x16_bf16 v[56:71], v[196:199], v[148:151], v[56:71]
  v_exp_f32 v116, v116
  v_exp_f32 v117, v117
  v_exp_f32 v118, v118
  v_exp_f32 v119, v119
  v_cvt_pk_bf16_f32 v140, v112, v113
  v_cvt_pk_bf16_f32 v141, v114, v115
  v_cvt_pk_bf16_f32 v142, v116, v117
  v_cvt_pk_bf16_f32 v143, v118, v119
  s_waitcnt vmcnt(2)
  v_mfma_f32_32x32x16_bf16 v[104:119], v[200:203], v[8:11], 0
  v_exp_f32 v120, v120
  v_exp_f32 v121, v121
  v_exp_f32 v122, v122
  v_exp_f32 v123, v123
  v_mfma_f32_32x32x16_bf16 v[104:119], v[204:207], v[12:15], v[104:119]
  v_exp_f32 v124, v124
  v_exp_f32 v125, v125
  v_exp_f32 v126, v126
  v_exp_f32 v127, v127
  v_cvt_pk_bf16_f32 v144, v120, v121
  v_cvt_pk_bf16_f32 v145, v122, v123
  v_mfma_f32_32x32x16_bf16 v[72:87], v[192:195], v[136:139], v[72:87]
  v_exp_f32 v128, v128
  v_exp_f32 v129, v129
  v_exp_f32 v130, v130
  v_exp_f32 v131, v131
  v_cvt_pk_bf16_f32 v146, v124, v125
  v_cvt_pk_bf16_f32 v147, v126, v127
  v_mfma_f32_32x32x16_bf16 v[72:87], v[196:199], v[140:143], v[72:87]
  v_exp_f32 v132, v132
  v_exp_f32 v133, v133
  v_exp_f32 v134, v134
  v_exp_f32 v135, v135
  v_cvt_pk_bf16_f32 v148, v128, v129
  v_cvt_pk_bf16_f32 v149, v130, v131
  v_cvt_pk_bf16_f32 v150, v132, v133
  v_cvt_pk_bf16_f32 v151, v134, v135
  v_mfma_f32_32x32x16_bf16 v[120:135], v[200:203], v[16:19], 0
  v_exp_f32 v104, v104
  v_exp_f32 v105, v105
  v_exp_f32 v106, v106
  v_exp_f32 v107, v107
  v_mfma_f32_32x32x16_bf16 v[120:135], v[204:207], v[20:23], v[120:135]
  v_exp_f32 v108, v108
  v_exp_f32 v109, v109
  v_exp_f32 v110, v110
  v_exp_f32 v111, v111
  v_cvt_pk_bf16_f32 v136, v104, v105
  v_cvt_pk_bf16_f32 v137, v106, v107
  v_mfma_f32_32x32x16_bf16 v[88:103], v[192:195], v[144:147], v[88:103]
  v_exp_f32 v112, v112
  v_exp_f32 v113, v113
  v_exp_f32 v114, v114
  v_exp_f32 v115, v115
  v_cvt_pk_bf16_f32 v138, v108, v109
  v_cvt_pk_bf16_f32 v139, v110, v111
  v_mfma_f32_32x32x16_bf16 v[88:103], v[196:199], v[148:151], v[88:103]
  v_exp_f32 v116, v116
  v_exp_f32 v117, v117
  v_exp_f32 v118, v118
  v_exp_f32 v119, v119
  v_cvt_pk_bf16_f32 v140, v112, v113
  v_cvt_pk_bf16_f32 v141, v114, v115
  v_cvt_pk_bf16_f32 v142, v116, v117
  v_cvt_pk_bf16_f32 v143, v118, v119
  v_mfma_f32_32x32x16_bf16 v[104:119], v[200:203], v[24:27], 0
  v_exp_f32 v120, v120
  v_exp_f32 v121, v121
  v_exp_f32 v122, v122
  v_exp_f32 v123, v123
  v_mfma_f32_32x32x16_bf16 v[104:119], v[204:207], v[28:31], v[104:119]
  v_exp_f32 v124, v124
  v_exp_f32 v125, v125
  v_exp_f32 v126, v126
  v_exp_f32 v127, v127
  v_cvt_pk_bf16_f32 v144, v120, v121
  v_cvt_pk_bf16_f32 v145, v122, v123
  s_waitcnt vmcnt(0)
  v_mfma_f32_32x32x16_bf16 v[40:55], v[208:211], v[136:139], v[40:55]
  v_exp_f32 v128, v128
  v_exp_f32 v129, v129
  v_exp_f32 v130, v130
  v_exp_f32 v131, v131
  v_cvt_pk_bf16_f32 v146, v124, v125
  v_cvt_pk_bf16_f32 v147, v126, v127
  v_mfma_f32_32x32x16_bf16 v[40:55], v[212:215], v[140:143], v[40:55]
  v_exp_f32 v132, v132
  v_exp_f32 v133, v133
  v_exp_f32 v134, v134
  v_exp_f32 v135, v135
  v_cvt_pk_bf16_f32 v148, v128, v129
  v_cvt_pk_bf16_f32 v149, v130, v131
  v_cvt_pk_bf16_f32 v150, v132, v133
  v_cvt_pk_bf16_f32 v151, v134, v135
  v_mfma_f32_32x32x16_bf16 v[120:135], v[200:203], v[32:35], 0
  v_exp_f32 v104, v104
  v_exp_f32 v105, v105
  s_nop 0
  v_exp_f32 v106, v106
  v_exp_f32 v107, v107
  v_mfma_f32_32x32x16_bf16 v[120:135], v[204:207], v[36:39], v[120:135]
  v_exp_f32 v108, v108
  v_exp_f32 v109, v109
  ds_write_b128 v250, v[40:43] offset:0
  v_exp_f32 v110, v110
  v_exp_f32 v111, v111
  v_cvt_pk_bf16_f32 v136, v104, v105
  v_cvt_pk_bf16_f32 v137, v106, v107
  v_mfma_f32_32x32x16_bf16 v[56:71], v[208:211], v[144:147], v[56:71]
  v_exp_f32 v112, v112
  v_exp_f32 v113, v113
  ds_write_b128 v250, v[44:47] offset:1024
  v_exp_f32 v114, v114
  v_exp_f32 v115, v115
  v_cvt_pk_bf16_f32 v138, v108, v109
  v_cvt_pk_bf16_f32 v139, v110, v111
  v_mfma_f32_32x32x16_bf16 v[56:71], v[212:215], v[148:151], v[56:71]
  v_exp_f32 v116, v116
  v_exp_f32 v117, v117
  ds_write_b128 v250, v[48:51] offset:2048
  v_exp_f32 v118, v118
  v_exp_f32 v119, v119
  v_cvt_pk_bf16_f32 v140, v112, v113
  v_cvt_pk_bf16_f32 v141, v114, v115
  v_cvt_pk_bf16_f32 v142, v116, v117
  v_cvt_pk_bf16_f32 v143, v118, v119
  v_exp_f32 v120, v120
  v_exp_f32 v121, v121
  ds_write_b128 v250, v[52:55] offset:3072
  v_exp_f32 v122, v122
  v_exp_f32 v123, v123
  v_exp_f32 v124, v124
  v_exp_f32 v125, v125
  s_nop 0
  v_exp_f32 v126, v126
  v_exp_f32 v127, v127
  v_cvt_pk_bf16_f32 v144, v120, v121
  v_cvt_pk_bf16_f32 v145, v122, v123
  v_mfma_f32_32x32x16_bf16 v[72:87], v[208:211], v[136:139], v[72:87]
  v_exp_f32 v128, v128
  v_exp_f32 v129, v129
  ds_write_b128 v251, v[56:59] offset:4096
  v_exp_f32 v130, v130
  v_exp_f32 v131, v131
  v_cvt_pk_bf16_f32 v146, v124, v125
  v_cvt_pk_bf16_f32 v147, v126, v127
  v_mfma_f32_32x32x16_bf16 v[72:87], v[212:215], v[140:143], v[72:87]
  v_exp_f32 v132, v132
  v_exp_f32 v133, v133
  ds_write_b128 v251, v[60:63] offset:5120
  v_exp_f32 v134, v134
  v_exp_f32 v135, v135
  v_cvt_pk_bf16_f32 v148, v128, v129
  v_cvt_pk_bf16_f32 v149, v130, v131
  v_cvt_pk_bf16_f32 v150, v132, v133
  v_cvt_pk_bf16_f32 v151, v134, v135
  s_setprio 3
  v_mfma_f32_32x32x16_bf16 v[88:103], v[208:211], v[144:147], v[88:103]
  v_mfma_f32_32x32x16_bf16 v[88:103], v[212:215], v[148:151], v[88:103]
  ds_write_b128 v251, v[64:67] offset:6144
  ds_write_b128 v251, v[68:71] offset:7168
  ds_write_b128 v252, v[72:75] offset:8192
  ds_write_b128 v252, v[76:79] offset:9216
  ds_write_b128 v252, v[80:83] offset:10240
  ds_write_b128 v252, v[84:87] offset:11264
  v_mov_b32 v5, 36868
  v_mov_b32 v6, 1
  s_mov_b64 exec, 1
  ds_add_u32 v5, v6
  s_mov_b64 exec, -1
  s_mul_i32 s11, s74, 12288
  s_cmp_eq_u32 s74, 3
  s_cselect_b32 s11, 139264, s11
  v_add_u32 v1, s11, v7
  s_lshl_b32 s7, s9, 2
  s_add_u32 s7, s7, 4
  v_mov_b32 v4, 36868
  s_mov_b32 s14, 0
lw_33:
  ds_read_b32 v5, v4
  s_add_u32 s14, s14, 1
  s_waitcnt lgkmcnt(0)
  v_readfirstlane_b32 s15, v5
  s_cmp_gt_u32 s14, 0x200000
  s_cbranch_scc1 lwe_34
  s_cmp_ge_u32 s15, s7
  s_cbranch_scc1 lwe_34
  s_branch lw_33
lwe_34:
  ds_read_b128 v[104:107], v1 offset:0
  ds_read_b128 v[108:111], v1 offset:1024
  ds_read_b128 v[112:115], v1 offset:2048
  ds_read_b128 v[116:119], v1 offset:3072
  ds_read_b128 v[120:123], v1 offset:4096
  ds_read_b128 v[124:127], v1 offset:5120
  ds_read_b128 v[128:131], v1 offset:6144
  ds_read_b128 v[132:135], v1 offset:7168
  ds_read_b128 v[136:139], v1 offset:8192
  ds_read_b128 v[140:143], v1 offset:9216
  ds_read_b128 v[144:147], v1 offset:10240
  ds_read_b128 v[148:151], v1 offset:11264
  s_waitcnt lgkmcnt(8)
  v_add_f32 v88, v88, v104
  v_add_f32 v89, v89, v105
  v_add_f32 v90, v90, v106
  v_add_f32 v91, v91, v107
  v_add_f32 v92, v92, v108
  v_add_f32 v93, v93, v109
  v_add_f32 v94, v94, v110
  v_add_f32 v95, v95, v111
  v_add_f32 v96, v96, v112
  v_add_f32 v97, v97, v113
  v_add_f32 v98, v98, v114
  v_add_f32 v99, v99, v115
  v_add_f32 v100, v100, v116
  v_add_f32 v101, v101, v117
  v_add_f32 v102, v102, v118
  v_add_f32 v103, v103, v119
  s_waitcnt lgkmcnt(4)
  v_add_f32 v88, v88, v120
  v_add_f32 v89, v89, v121
  v_add_f32 v90, v90, v122
  v_add_f32 v91, v91, v123
  v_add_f32 v92, v92, v124
  v_add_f32 v93, v93, v125
  v_add_f32 v94, v94, v126
  v_add_f32 v95, v95, v127
  v_add_f32 v96, v96, v128
  v_add_f32 v97, v97, v129
  v_add_f32 v98, v98, v130
  v_add_f32 v99, v99, v131
  v_add_f32 v100, v100, v132
  v_add_f32 v101, v101, v133
  v_add_f32 v102, v102, v134
  v_add_f32 v103, v103, v135
  s_waitcnt lgkmcnt(0)
  v_add_f32 v88, v88, v136
  v_add_f32 v89, v89, v137
  v_add_f32 v90, v90, v138
  v_add_f32 v91, v91, v139
  v_add_f32 v92, v92, v140
  v_add_f32 v93, v93, v141
  v_add_f32 v94, v94, v142
  v_add_f32 v95, v95, v143
  v_add_f32 v96, v96, v144
  v_add_f32 v97, v97, v145
  v_add_f32 v98, v98, v146
  v_add_f32 v99, v99, v147
  v_add_f32 v100, v100, v148
  v_add_f32 v101, v101, v149
  v_add_f32 v102, v102, v150
  v_add_f32 v103, v103, v151
  v_mov_b32 v4, v100
  v_mov_b32 v5, v100
  s_lshl_b32 s3, s72, 2
  s_add_u32 s3, s3, s74
  v_permlane32_swap_b32 v4, v5
  s_lshl_b32 s3, s3, 4
  s_add_u32 s3, s3, s73
  v_rcp_f32 v4, v5
  s_lshl_b32 s7, s3, 11
  s_add_u32 s7, s7, 14680064
  v_mul_f32 v4, v4, v3
  s_lshl_b32 s11, s3, 3
  s_add_u32 s11, s11, 16859136
  v_mul_f32 v88, v4, v88
  v_mul_f32 v89, v4, v89
  v_mul_f32 v90, v4, v90
  v_mul_f32 v91, v4, v91
  v_mul_f32 v92, v4, v92
  v_mul_f32 v93, v4, v93
  v_mul_f32 v94, v4, v94
  v_mul_f32 v95, v4, v95
  v_mul_f32 v96, v4, v96
  v_mul_f32 v97, v4, v97
  v_mul_f32 v98, v4, v98
  v_mul_f32 v99, v4, v99
  v_mul_f32 v100, v4, v100
  v_mul_f32 v101, v4, v101
  v_mul_f32 v102, v4, v102
  v_mul_f32 v103, v4, v103
  v_cvt_pk_bf16_f32 v104, v88, v89
  v_cvt_pk_bf16_f32 v105, v90, v91
  v_cvt_pk_bf16_f32 v106, v92, v93
  v_cvt_pk_bf16_f32 v107, v94, v95
  v_cvt_pk_bf16_f32 v108, v96, v97
  v_cvt_pk_bf16_f32 v109, v98, v99
  v_cvt_pk_bf16_f32 v110, v100, v101
  v_cvt_pk_bf16_f32 v111, v102, v103
  s_cmp_lg_u32 s10, 0
  s_cbranch_scc1 k_a_done
  s_mov_b32 exec_lo, 0
  v_mov_b32 v110, 0
  v_mov_b32 v111, 0
  s_mov_b64 exec, -1
  buffer_store_dwordx4 v[104:107], v7, s[44:47], s7 offen sc1
  buffer_store_dwordx4 v[108:111], v7, s[44:47], s7 offen offset:1024 sc1
  v_add_f32 v88, v88, v90
  v_add_f32 v89, v89, v91
  v_add_f32 v88, v88, v92
  v_add_f32 v89, v89, v93
  v_add_f32 v88, v88, v94
  v_add_f32 v89, v89, v95
  v_add_f32 v88, v88, v96
  v_add_f32 v89, v89, v97
  v_add_f32 v88, v88, v98
  v_add_f32 v89, v89, v99
  v_add_f32 v88, v88, v100
  v_add_f32 v89, v89, v101
  v_add_f32 v88, v88, v102
  v_add_f32 v89, v89, v103
  v_add_f32 v88, v88, v89
  v_mul_f32 v88, 0, v88
  v_add_f32 v5, v5, v88
  v_mov_b32 v6, 0x53800000
  v_cmp_nlt_f32 vcc, v5, v6
  s_cmp_lg_u32 s9, 0
  s_cbranch_scc1 k_a_pub
  s_cbranch_vccz k_a_pub
  v_mov_b32 v4, 36872
  v_mov_b32 v6, 1
  ds_write_b32 v4, v6
  s_branch k_a_sync
k_a_pub:
  s_waitcnt vmcnt(0)
  v_mov_b32 v4, s12
  v_mov_b32 v5, s13
  v_mov_b32 v6, 0
  s_mov_b64 exec, 1
  buffer_store_dwordx2 v[4:5], v6, s[44:47], s11 offen sc1
  s_mov_b64 exec, -1
  s_mov_b32 s10, 1
k_a_sync:
  s_cmp_lg_u32 s9, 0
  s_cbranch_scc1 k_a_done
  v_mov_b32 v4, 36876
  v_mov_b32 v5, 1
  s_mov_b64 exec, 1
  ds_add_u32 v4, v5
  s_mov_b64 exec, -1
  v_mov_b32 v4, 36876
  s_mov_b32 s14, 0
lw_35:
  ds_read_b32 v5, v4
  s_add_u32 s14, s14, 1
  s_waitcnt lgkmcnt(0)
  v_readfirstlane_b32 s15, v5
  s_cmp_gt_u32 s14, 0x200000
  s_cbranch_scc1 lwe_36
  s_cmp_ge_u32 s15, 4
  s_cbranch_scc1 lwe_36
  s_branch lw_35
lwe_36:
  v_mov_b32 v4, 36872
  ds_read_b32 v6, v4
  s_waitcnt lgkmcnt(0)
  v_readfirstlane_b32 s3, v6
  s_cmp_lg_u32 s3, 0
  s_cbranch_scc1 k_fallback
k_a_done:
  s_endpgm
k_fallback:
  s_mov_b32 s9, 1
  s_waitcnt vmcnt(0)
  s_mov_b32 exec_lo, 0
  v_mov_b32 v14, 0
  v_mov_b32 v15, 0
  v_mov_b32 v22, 0
  v_mov_b32 v23, 0
  v_mov_b32 v30, 0
  v_mov_b32 v31, 0
  v_mov_b32 v38, 0
  v_mov_b32 v39, 0
  s_mov_b64 exec, -1
  v_mov_b32 v40, 0xff800000
  v_mov_b32 v41, 0xff800000
  v_mov_b32 v42, 0xff800000
  v_mov_b32 v43, 0xff800000
  s_mov_b32 s6, 0
k_fbloop:
  buffer_load_dwordx4 v[152:155], v7, s[48:51], s6 offen sc1
  buffer_load_dwordx4 v[156:159], v7, s[48:51], s6 offen offset:1024 sc1
  s_add_u32 s6, s6, 4096
  s_waitcnt vmcnt(0)
  v_mfma_f32_32x32x16_bf16 v[104:119], v[152:155], v[8:11], 0
  v_mfma_f32_32x32x16_bf16 v[104:119], v[156:159], v[12:15], v[104:119]
  s_nop 15
  v_max3_f32 v40, v40, v104, v105
  v_max3_f32 v40, v40, v106, v107
  v_max3_f32 v40, v40, v108, v109
  v_max3_f32 v40, v40, v110, v111
  v_max3_f32 v40, v40, v112, v113
  v_max3_f32 v40, v40, v114, v115
  v_max3_f32 v40, v40, v116, v117
  v_max3_f32 v40, v40, v118, v119
  v_mfma_f32_32x32x16_bf16 v[104:119], v[152:155], v[16:19], 0
  v_mfma_f32_32x32x16_bf16 v[104:119], v[156:159], v[20:23], v[104:119]
  s_nop 15
  v_max3_f32 v41, v41, v104, v105
  v_max3_f32 v41, v41, v106, v107
  v_max3_f32 v41, v41, v108, v109
  v_max3_f32 v41, v41, v110, v111
  v_max3_f32 v41, v41, v112, v113
  v_max3_f32 v41, v41, v114, v115
  v_max3_f32 v41, v41, v116, v117
  v_max3_f32 v41, v41, v118, v119
  v_mfma_f32_32x32x16_bf16 v[104:119], v[152:155], v[24:27], 0
  v_mfma_f32_32x32x16_bf16 v[104:119], v[156:159], v[28:31], v[104:119]
  s_nop 15
  v_max3_f32 v42, v42, v104, v105
  v_max3_f32 v42, v42, v106, v107
  v_max3_f32 v42, v42, v108, v109
  v_max3_f32 v42, v42, v110, v111
  v_max3_f32 v42, v42, v112, v113
  v_max3_f32 v42, v42, v114, v115
  v_max3_f32 v42, v42, v116, v117
  v_max3_f32 v42, v42, v118, v119
  v_mfma_f32_32x32x16_bf16 v[104:119], v[152:155], v[32:35], 0
  v_mfma_f32_32x32x16_bf16 v[104:119], v[156:159], v[36:39], v[104:119]
  s_nop 15
  v_max3_f32 v43, v43, v104, v105
  v_max3_f32 v43, v43, v106, v107
  v_max3_f32 v43, v43, v108, v109
  v_max3_f32 v43, v43, v110, v111
  v_max3_f32 v43, v43, v112, v113
  v_max3_f32 v43, v43, v114, v115
  v_max3_f32 v43, v43, v116, v117
  v_max3_f32 v43, v43, v118, v119
  s_cmp_lt_u32 s6, 65536
  s_cbranch_scc1 k_fbloop
  s_add_u32 s3, s74, 1
  s_and_b32 s3, s3, 3
  s_lshl_b32 s3, s3, 10
  s_lshl_b32 s11, s74, 8
  s_add_u32 s3, s3, s11
  v_lshl_add_u32 v4, v0, 2, s3
  ds_write_b32 v4, v40
  s_add_u32 s3, s74, 2
  s_and_b32 s3, s3, 3
  s_lshl_b32 s3, s3, 10
  s_lshl_b32 s11, s74, 8
  s_add_u32 s3, s3, s11
  v_lshl_add_u32 v4, v0, 2, s3
  ds_write_b32 v4, v41
  s_add_u32 s3, s74, 3
  s_and_b32 s3, s3, 3
  s_lshl_b32 s3, s3, 10
  s_lshl_b32 s11, s74, 8
  s_add_u32 s3, s3, s11
  v_lshl_add_u32 v4, v0, 2, s3
  ds_write_b32 v4, v42
  s_add_u32 s3, s74, 4
  s_and_b32 s3, s3, 3
  s_lshl_b32 s3, s3, 10
  s_lshl_b32 s11, s74, 8
  s_add_u32 s3, s3, s11
  v_lshl_add_u32 v4, v0, 2, s3
  ds_write_b32 v4, v43
  v_mov_b32 v4, 36884
  v_mov_b32 v5, 1
  s_mov_b64 exec, 1
  ds_add_u32 v4, v5
  s_mov_b64 exec, -1
  v_mov_b32 v4, 36884
  s_mov_b32 s14, 0
lw_37:
  ds_read_b32 v5, v4
  s_add_u32 s14, s14, 1
  s_waitcnt lgkmcnt(0)
  v_readfirstlane_b32 s15, v5
  s_cmp_gt_u32 s14, 0x200000
  s_cbranch_scc1 lwe_38
  s_cmp_ge_u32 s15, 4
  s_cbranch_scc1 lwe_38
  s_branch lw_37
lwe_38:
  s_add_u32 s3, s74, 1
  s_and_b32 s3, s3, 3
  s_lshl_b32 s3, s3, 10
  v_lshl_add_u32 v4, v2, 2, s3
  ds_read_b32 v48, v4 offset:0
  ds_read_b32 v49, v4 offset:128
  ds_read_b32 v50, v4 offset:256
  ds_read_b32 v51, v4 offset:384
  ds_read_b32 v52, v4 offset:512
  ds_read_b32 v53, v4 offset:640
  ds_read_b32 v54, v4 offset:768
  ds_read_b32 v55, v4 offset:896
  s_waitcnt lgkmcnt(0)
  v_max3_f32 v5, v48, v49, v50
  v_max3_f32 v5, v5, v51, v52
  v_max3_f32 v5, v5, v53, v54
  v_max_f32 v5, v5, v55
  v_sub_f32 v5, 0, v5
  v_and_b32 v6, 0xffff0000, v5
  v_sub_f32 v6, v5, v6
  v_and_b32 v4, 0xffff0000, v6
  v_sub_f32 v4, v6, v4
  s_mov_b32 s3, 0x07060302
  s_mov_b32 exec_lo, 0
  v_perm_b32 v14, v6, v5, s3
  v_lshrrev_b32 v15, 16, v4
  s_mov_b64 exec, -1
  s_add_u32 s3, s74, 2
  s_and_b32 s3, s3, 3
  s_lshl_b32 s3, s3, 10
  v_lshl_add_u32 v4, v2, 2, s3
  ds_read_b32 v48, v4 offset:0
  ds_read_b32 v49, v4 offset:128
  ds_read_b32 v50, v4 offset:256
  ds_read_b32 v51, v4 offset:384
  ds_read_b32 v52, v4 offset:512
  ds_read_b32 v53, v4 offset:640
  ds_read_b32 v54, v4 offset:768
  ds_read_b32 v55, v4 offset:896
  s_waitcnt lgkmcnt(0)
  v_max3_f32 v5, v48, v49, v50
  v_max3_f32 v5, v5, v51, v52
  v_max3_f32 v5, v5, v53, v54
  v_max_f32 v5, v5, v55
  v_sub_f32 v5, 0, v5
  v_and_b32 v6, 0xffff0000, v5
  v_sub_f32 v6, v5, v6
  v_and_b32 v4, 0xffff0000, v6
  v_sub_f32 v4, v6, v4
  s_mov_b32 s3, 0x07060302
  s_mov_b32 exec_lo, 0
  v_perm_b32 v22, v6, v5, s3
  v_lshrrev_b32 v23, 16, v4
  s_mov_b64 exec, -1
  s_add_u32 s3, s74, 3
  s_and_b32 s3, s3, 3
  s_lshl_b32 s3, s3, 10
  v_lshl_add_u32 v4, v2, 2, s3
  ds_read_b32 v48, v4 offset:0
  ds_read_b32 v49, v4 offset:128
  ds_read_b32 v50, v4 offset:256
  ds_read_b32 v51, v4 offset:384
  ds_read_b32 v52, v4 offset:512
  ds_read_b32 v53, v4 offset:640
  ds_read_b32 v54, v4 offset:768
  ds_read_b32 v55, v4 offset:896
  s_waitcnt lgkmcnt(0)
  v_max3_f32 v5, v48, v49, v50
  v_max3_f32 v5, v5, v51, v52
  v_max3_f32 v5, v5, v53, v54
  v_max_f32 v5, v5, v55
  v_sub_f32 v5, 0, v5
  v_and_b32 v6, 0xffff0000, v5
  v_sub_f32 v6, v5, v6
  v_and_b32 v4, 0xffff0000, v6
  v_sub_f32 v4, v6, v4
  s_mov_b32 s3, 0x07060302
  s_mov_b32 exec_lo, 0
  v_perm_b32 v30, v6, v5, s3
  v_lshrrev_b32 v31, 16, v4
  s_mov_b64 exec, -1
  s_add_u32 s3, s74, 4
  s_and_b32 s3, s3, 3
  s_lshl_b32 s3, s3, 10
  v_lshl_add_u32 v4, v2, 2, s3
  ds_read_b32 v48, v4 offset:0
  ds_read_b32 v49, v4 offset:128
  ds_read_b32 v50, v4 offset:256
  ds_read_b32 v51, v4 offset:384
  ds_read_b32 v52, v4 offset:512
  ds_read_b32 v53, v4 offset:640
  ds_read_b32 v54, v4 offset:768
  ds_read_b32 v55, v4 offset:896
  s_waitcnt lgkmcnt(0)
  v_max3_f32 v5, v48, v49, v50
  v_max3_f32 v5, v5, v51, v52
  v_max3_f32 v5, v5, v53, v54
  v_max_f32 v5, v5, v55
  v_sub_f32 v5, 0, v5
  v_and_b32 v6, 0xffff0000, v5
  v_sub_f32 v6, v5, v6
  v_and_b32 v4, 0xffff0000, v6
  v_sub_f32 v4, v6, v4
  s_mov_b32 s3, 0x07060302
  s_mov_b32 exec_lo, 0
  v_perm_b32 v38, v6, v5, s3
  v_lshrrev_b32 v39, 16, v4
  s_mov_b64 exec, -1
  v_mov_b32 v4, 36888
  v_mov_b32 v5, 1
  s_mov_b64 exec, 1
  ds_add_u32 v4, v5
  s_mov_b64 exec, -1
  v_mov_b32 v4, 36888
  s_mov_b32 s14, 0
lw_39:
  ds_read_b32 v5, v4
  s_add_u32 s14, s14, 1
  s_waitcnt lgkmcnt(0)
  v_readfirstlane_b32 s15, v5
  s_cmp_gt_u32 s14, 0x200000
  s_cbranch_scc1 lwe_40
  s_cmp_ge_u32 s15, 4
  s_cbranch_scc1 lwe_40
  s_branch lw_39
lwe_40:
  s_branch k_att_start
k_F:
  s_setprio 2
  s_mov_b32 s68, s32
  s_mov_b32 s69, s33
  s_mov_b32 s70, 256
  s_mov_b32 s71, 0x00020000
  v_lshlrev_b32 v1, 2, v0
  v_add_u32 v1, 36864, v1
  v_mov_b32 v15, 0
  ds_write_b32 v1, v15
  s_or_b32 s3, s2, s74
  s_cmp_lg_u32 s3, 0
  s_cbranch_scc1 k_F_nonce_done
  s_memrealtime s[4:5]
  s_waitcnt lgkmcnt(0)
  s_or_b32 s4, s4, 1
  v_mov_b32 v18, s4
  v_mov_b32 v19, s5
  s_mov_b64 exec, 1
  buffer_store_dwordx2 v[18:19], v15, s[68:71], 0 offen sc1
  s_mov_b64 exec, -1
k_F_nonce_done:
  s_mov_b32 s44, s34
  s_mov_b32 s45, s35
  s_mov_b32 s46, 16908288
  s_mov_b32 s47, 0x00020000
  s_mov_b32 s48, s24
  s_mov_b32 s49, s25
  s_mov_b32 s50, 1605632
  s_mov_b32 s51, 0x00020000
  v_bfe_u32 v14, v0, 1, 3
  v_lshlrev_b32 v15, 7, v2
  v_add_u32 v1, 0, v3
  v_xor_b32 v1, v1, v14
  v_lshl_add_u32 v8, v1, 4, v15
  v_add_u32 v1, 2, v3
  v_xor_b32 v1, v1, v14
  v_lshl_add_u32 v9, v1, 4, v15
  v_add_u32 v1, 4, v3
  v_xor_b32 v1, v1, v14
  v_lshl_add_u32 v10, v1, 4, v15
  v_add_u32 v1, 6, v3
  v_xor_b32 v1, v1, v14
  v_lshl_add_u32 v11, v1, 4, v15
  s_cmp_ge_u32 s73, 14
  s_cbranch_scc1 k_gate
  v_lshrrev_b32 v14, 2, v0
  v_mul_u32_u24 v14, 3584, v14
  v_lshl_add_u32 v14, v6, 4, v14
  s_lshl_b32 s9, s73, 2
  s_add_u32 s9, s9, s74
  s_lshl_b32 s10, s9, 6
  s_mul_i32 s3, s11, 229376
  s_add_u32 s10, s10, s3
  s_sub_u32 s10, s10, 57344
  s_and_b32 s4, s72, 7
  s_mul_i32 s4, s4, 56
  s_mul_i32 s5, s74, 14
  s_add_u32 s4, s4, s5
  s_mul_i32 s4, s4, 3584
  s_lshl_b32 s5, s73, 8
  s_add_u32 s4, s4, s5
  v_lshrrev_b32 v13, 1, v0
  v_mul_u32_u24 v13, 3584, v13
  v_and_b32 v15, 1, v0
  v_lshl_add_u32 v13, v15, 7, v13
  v_cmp_gt_u32 vcc, 28, v0
  v_bfrev_b32 v15, 1
  s_nop 0
  v_cndmask_b32 v13, v15, v13, vcc
  buffer_load_dword v251, v13, s[48:51], s4 offen
  v_add_u32 v8, 49152, v8
  v_add_u32 v9, 49152, v9
  v_add_u32 v10, 49152, v10
  v_add_u32 v11, 49152, v11
  v_lshl_add_u32 v15, v3, 3, v4
  v_lshlrev_b32 v15, 6, v15
  v_lshl_add_u32 v15, v5, 5, v15
  v_lshl_add_u32 v15, v6, 3, v15
  s_lshl_b32 s4, s74, 11
  s_add_u32 s4, s4, 37888
  v_add_u32 v12, s4, v15
  v_add_u32 v13, s4, v7
  v_mov_b32 v16, 0
  v_mov_b32 v17, 0
  v_mov_b32 v18, 0
  v_mov_b32 v19, 0
  s_nop 1
  v_mfma_f32_32x32x16_bf16 v[48:63], v[16:19], v[16:19], 0
  v_mfma_f32_32x32x16_bf16 v[64:79], v[16:19], v[16:19], 0
  v_mfma_f32_32x32x16_bf16 v[80:95], v[16:19], v[16:19], 0
  v_mfma_f32_32x32x16_bf16 v[96:111], v[16:19], v[16:19], 0
  s_waitcnt lgkmcnt(0)
  s_barrier
  v_mov_b32 v1, 36908
  s_mov_b32 s14, 0
lw_41:
  ds_read_b32 v15, v1
  s_add_u32 s14, s14, 1
  s_waitcnt lgkmcnt(0)
  v_readfirstlane_b32 s15, v15
  s_cmp_gt_u32 s14, 0x200000
  s_cbranch_scc1 lwe_42
  s_cmp_ge_u32 s15, 4
  s_cbranch_scc1 lwe_42
  s_sleep 1
  s_branch lw_41
lwe_42:
  s_add_u32 s10, s10, 57344
  buffer_load_dwordx4 v[112:115], v14, s[48:51], s10 offen
  s_add_u32 s10, s10, 57344
  buffer_load_dwordx4 v[116:119], v14, s[48:51], s10 offen
  s_add_u32 s10, s10, 57344
  buffer_load_dwordx4 v[120:123], v14, s[48:51], s10 offen
  s_add_u32 s10, s10, 57344
  buffer_load_dwordx4 v[124:127], v14, s[48:51], s10 offen
  s_add_u32 s11, s11, 1
  s_cmp_eq_u32 s11, 7
  s_cselect_b32 s3, 1605632, 0
  s_sub_u32 s10, s10, s3
  s_add_u32 s10, s10, 57344
  buffer_load_dwordx4 v[128:131], v14, s[48:51], s10 offen
  s_add_u32 s10, s10, 57344
  buffer_load_dwordx4 v[132:135], v14, s[48:51], s10 offen
  s_add_u32 s10, s10, 57344
  buffer_load_dwordx4 v[136:139], v14, s[48:51], s10 offen
  s_add_u32 s10, s10, 57344
  buffer_load_dwordx4 v[140:143], v14, s[48:51], s10 offen
  s_add_u32 s11, s11, 1
  s_cmp_eq_u32 s11, 7
  s_cselect_b32 s3, 1605632, 0
  s_sub_u32 s10, s10, s3
  s_add_u32 s10, s10, 57344
  buffer_load_dwordx4 v[144:147], v14, s[48:51], s10 offen
  s_add_u32 s10, s10, 57344
  buffer_load_dwordx4 v[148:151], v14, s[48:51], s10 offen
  s_add_u32 s10, s10, 57344
  buffer_load_dwordx4 v[152:155], v14, s[48:51], s10 offen
  s_add_u32 s10, s10, 57344
  buffer_load_dwordx4 v[156:159], v14, s[48:51], s10 offen
  s_add_u32 s11, s11, 1
  s_cmp_eq_u32 s11, 7
  s_cselect_b32 s3, 1605632, 0
  s_sub_u32 s10, s10, s3
  s_add_u32 s10, s10, 57344
  buffer_load_dwordx4 v[160:163], v14, s[48:51], s10 offen
  s_add_u32 s10, s10, 57344
  buffer_load_dwordx4 v[164:167], v14, s[48:51], s10 offen
  s_add_u32 s10, s10, 57344
  buffer_load_dwordx4 v[168:171], v14, s[48:51], s10 offen
  s_add_u32 s10, s10, 57344
  buffer_load_dwordx4 v[172:175], v14, s[48:51], s10 offen
  s_add_u32 s11, s11, 1
  s_cmp_eq_u32 s11, 7
  s_cselect_b32 s3, 1605632, 0
  s_sub_u32 s10, s10, s3
  s_add_u32 s10, s10, 57344
  buffer_load_dwordx4 v[176:179], v14, s[48:51], s10 offen
  s_add_u32 s10, s10, 57344
  buffer_load_dwordx4 v[180:183], v14, s[48:51], s10 offen
  s_add_u32 s10, s10, 57344
  buffer_load_dwordx4 v[184:187], v14, s[48:51], s10 offen
  s_add_u32 s10, s10, 57344
  buffer_load_dwordx4 v[188:191], v14, s[48:51], s10 offen
  s_add_u32 s11, s11, 1
  s_cmp_eq_u32 s11, 7
  s_cselect_b32 s3, 1605632, 0
  s_sub_u32 s10, s10, s3
  s_add_u32 s10, s10, 57344
  buffer_load_dwordx4 v[192:195], v14, s[48:51], s10 offen
  s_add_u32 s10, s10, 57344
  buffer_load_dwordx4 v[196:199], v14, s[48:51], s10 offen
  s_add_u32 s10, s10, 57344
  buffer_load_dwordx4 v[200:203], v14, s[48:51], s10 offen
  s_add_u32 s10, s10, 57344
  buffer_load_dwordx4 v[204:207], v14, s[48:51], s10 offen
  s_add_u32 s11, s11, 1
  s_cmp_eq_u32 s11, 7
  s_cselect_b32 s3, 1605632, 0
  s_sub_u32 s10, s10, s3
  s_add_u32 s10, s10, 57344
  buffer_load_dwordx4 v[208:211], v14, s[48:51], s10 offen
  s_add_u32 s10, s10, 57344
  buffer_load_dwordx4 v[212:215], v14, s[48:51], s10 offen
  s_add_u32 s10, s10, 57344
  buffer_load_dwordx4 v[216:219], v14, s[48:51], s10 offen
  s_add_u32 s10, s10, 57344
  buffer_load_dwordx4 v[220:223], v14, s[48:51], s10 offen
  s_add_u32 s11, s11, 1
  s_cmp_eq_u32 s11, 7
  s_cselect_b32 s3, 1605632, 0
  s_sub_u32 s10, s10, s3
  s_waitcnt vmcnt(27)
  ds_write_b128 v13, v[112:115] offset:0
  ds_read_b64_tr_b16 v[240:241], v12 offset:0
  ds_read_b64_tr_b16 v[242:243], v12 offset:256
  s_waitcnt vmcnt(26)
  ds_write_b128 v13, v[116:119] offset:1024
  v_mov_b32 v1, 36908
  s_mov_b32 s14, 0
lw_43:
  ds_read_b32 v15, v1
  s_add_u32 s14, s14, 1
  s_waitcnt lgkmcnt(0)
  v_readfirstlane_b32 s15, v15
  s_cmp_gt_u32 s14, 0x200000
  s_cbranch_scc1 lwe_44
  s_cmp_ge_u32 s15, 28
  s_cbranch_scc1 lwe_44
  s_sleep 1
  s_branch lw_43
lwe_44:
  ds_read_b128 v[16:19], v8 offset:0
  ds_read_b128 v[20:23], v8 offset:4096
  ds_read_b128 v[24:27], v8 offset:8192
  ds_read_b128 v[28:31], v8 offset:12288
  ds_read_b128 v[32:35], v9 offset:0
  ds_read_b128 v[36:39], v9 offset:4096
  ds_read_b128 v[40:43], v9 offset:8192
  ds_read_b128 v[44:47], v9 offset:12288
  s_waitcnt lgkmcnt(4)
  v_mfma_f32_32x32x16_bf16 v[48:63], v[240:243], v[16:19], v[48:63]
  ds_read_b64_tr_b16 v[244:245], v12 offset:1024
  ds_read_b64_tr_b16 v[246:247], v12 offset:1280
  v_mfma_f32_32x32x16_bf16 v[64:79], v[240:243], v[20:23], v[64:79]
  ds_read_b128 v[224:227], v10 offset:0
  ds_read_b128 v[228:231], v10 offset:4096
  v_mfma_f32_32x32x16_bf16 v[80:95], v[240:243], v[24:27], v[80:95]
  ds_read_b128 v[232:235], v10 offset:8192
  ds_read_b128 v[236:239], v10 offset:12288
  v_mfma_f32_32x32x16_bf16 v[96:111], v[240:243], v[28:31], v[96:111]
  s_waitcnt vmcnt(25)
  ds_write_b128 v13, v[120:123] offset:0
  s_waitcnt lgkmcnt(5)
  v_mfma_f32_32x32x16_bf16 v[48:63], v[244:247], v[32:35], v[48:63]
  ds_read_b64_tr_b16 v[240:241], v12 offset:0
  ds_read_b64_tr_b16 v[242:243], v12 offset:256
  v_mfma_f32_32x32x16_bf16 v[64:79], v[244:247], v[36:39], v[64:79]
  ds_read_b128 v[16:19], v11 offset:0
  ds_read_b128 v[20:23], v11 offset:4096
  v_mfma_f32_32x32x16_bf16 v[80:95], v[244:247], v[40:43], v[80:95]
  ds_read_b128 v[24:27], v11 offset:8192
  ds_read_b128 v[28:31], v11 offset:12288
  v_mfma_f32_32x32x16_bf16 v[96:111], v[244:247], v[44:47], v[96:111]
  s_waitcnt vmcnt(24)
  ds_write_b128 v13, v[124:127] offset:1024
  s_waitcnt lgkmcnt(5)
  v_mfma_f32_32x32x16_bf16 v[48:63], v[240:243], v[224:227], v[48:63]
  ds_read_b64_tr_b16 v[244:245], v12 offset:1024
  ds_read_b64_tr_b16 v[246:247], v12 offset:1280
  v_mfma_f32_32x32x16_bf16 v[64:79], v[240:243], v[228:231], v[64:79]
  ds_read_b128 v[32:35], v8 offset:16384
  ds_read_b128 v[36:39], v8 offset:20480
  v_mfma_f32_32x32x16_bf16 v[80:95], v[240:243], v[232:235], v[80:95]
  ds_read_b128 v[40:43], v8 offset:24576
  ds_read_b128 v[44:47], v8 offset:28672
  v_mfma_f32_32x32x16_bf16 v[96:111], v[240:243], v[236:239], v[96:111]
  s_waitcnt vmcnt(23)
  ds_write_b128 v13, v[128:131] offset:0
  s_waitcnt lgkmcnt(5)
  v_mfma_f32_32x32x16_bf16 v[48:63], v[244:247], v[16:19], v[48:63]
  ds_read_b64_tr_b16 v[240:241], v12 offset:0
  ds_read_b64_tr_b16 v[242:243], v12 offset:256
  v_mfma_f32_32x32x16_bf16 v[64:79], v[244:247], v[20:23], v[64:79]
  ds_read_b128 v[224:227], v9 offset:16384
  ds_read_b128 v[228:231], v9 offset:20480
  v_mfma_f32_32x32x16_bf16 v[80:95], v[244:247], v[24:27], v[80:95]
  ds_read_b128 v[232:235], v9 offset:24576
  ds_read_b128 v[236:239], v9 offset:28672
  v_mfma_f32_32x32x16_bf16 v[96:111], v[244:247], v[28:31], v[96:111]
  s_waitcnt vmcnt(22)
  ds_write_b128 v13, v[132:135] offset:1024
  s_waitcnt lgkmcnt(5)
  v_mfma_f32_32x32x16_bf16 v[48:63], v[240:243], v[32:35], v[48:63]
  ds_read_b64_tr_b16 v[244:245], v12 offset:1024
  ds_read_b64_tr_b16 v[246:247], v12 offset:1280
  v_mfma_f32_32x32x16_bf16 v[64:79], v[240:243], v[36:39], v[64:79]
  ds_read_b128 v[16:19], v10 offset:16384
  ds_read_b128 v[20:23], v10 offset:20480
  v_mfma_f32_32x32x16_bf16 v[80:95], v[240:243], v[40:43], v[80:95]
  ds_read_b128 v[24:27], v10 offset:24576
  ds_read_b128 v[28:31], v10 offset:28672
  v_mfma_f32_32x32x16_bf16 v[96:111], v[240:243], v[44:47], v[96:111]
  s_waitcnt vmcnt(21)
  ds_write_b128 v13, v[136:139] offset:0
  s_waitcnt lgkmcnt(5)
  v_mfma_f32_32x32x16_bf16 v[48:63], v[244:247], v[224:227], v[48:63]
  ds_read_b64_tr_b16 v[240:241], v12 offset:0
  ds_read_b64_tr_b16 v[242:243], v12 offset:256
  v_mfma_f32_32x32x16_bf16 v[64:79], v[244:247], v[228:231], v[64:79]
  ds_read_b128 v[32:35], v11 offset:16384
  ds_read_b128 v[36:39], v11 offset:20480
  v_mfma_f32_32x32x16_bf16 v[80:95], v[244:247], v[232:235], v[80:95]
  ds_read_b128 v[40:43], v11 offset:24576
  ds_read_b128 v[44:47], v11 offset:28672
  v_mfma_f32_32x32x16_bf16 v[96:111], v[244:247], v[236:239], v[96:111]
  s_waitcnt vmcnt(20)
  ds_write_b128 v13, v[140:143] offset:1024
  s_waitcnt lgkmcnt(5)
  v_mfma_f32_32x32x16_bf16 v[48:63], v[240:243], v[16:19], v[48:63]
  ds_read_b64_tr_b16 v[244:245], v12 offset:1024
  ds_read_b64_tr_b16 v[246:247], v12 offset:1280
  v_mfma_f32_32x32x16_bf16 v[64:79], v[240:243], v[20:23], v[64:79]
  ds_read_b128 v[224:227], v8 offset:32768
  ds_read_b128 v[228:231], v8 offset:36864
  v_mfma_f32_32x32x16_bf16 v[80:95], v[240:243], v[24:27], v[80:95]
  ds_read_b128 v[232:235], v8 offset:40960
  ds_read_b128 v[236:239], v8 offset:45056
  v_mfma_f32_32x32x16_bf16 v[96:111], v[240:243], v[28:31], v[96:111]
  s_waitcnt vmcnt(19)
  ds_write_b128 v13, v[144:147] offset:0
  s_waitcnt lgkmcnt(5)
  v_mfma_f32_32x32x16_bf16 v[48:63], v[244:247], v[32:35], v[48:63]
  ds_read_b64_tr_b16 v[240:241], v12 offset:0
  ds_read_b64_tr_b16 v[242:243], v12 offset:256
  v_mfma_f32_32x32x16_bf16 v[64:79], v[244:247], v[36:39], v[64:79]
  ds_read_b128 v[16:19], v9 offset:32768
  ds_read_b128 v[20:23], v9 offset:36864
  v_mfma_f32_32x32x16_bf16 v[80:95], v[244:247], v[40:43], v[80:95]
  ds_read_b128 v[24:27], v9 offset:40960
  ds_read_b128 v[28:31], v9 offset:45056
  v_mfma_f32_32x32x16_bf16 v[96:111], v[244:247], v[44:47], v[96:111]
  s_waitcnt vmcnt(18)
  ds_write_b128 v13, v[148:151] offset:1024
  s_waitcnt lgkmcnt(5)
  v_mfma_f32_32x32x16_bf16 v[48:63], v[240:243], v[224:227], v[48:63]
  ds_read_b64_tr_b16 v[244:245], v12 offset:1024
  ds_read_b64_tr_b16 v[246:247], v12 offset:1280
  v_mfma_f32_32x32x16_bf16 v[64:79], v[240:243], v[228:231], v[64:79]
  ds_read_b128 v[32:35], v10 offset:32768
  ds_read_b128 v[36:39], v10 offset:36864
  v_mfma_f32_32x32x16_bf16 v[80:95], v[240:243], v[232:235], v[80:95]
  ds_read_b128 v[40:43], v10 offset:40960
  ds_read_b128 v[44:47], v10 offset:45056
  v_mfma_f32_32x32x16_bf16 v[96:111], v[240:243], v[236:239], v[96:111]
  s_waitcnt vmcnt(17)
  ds_write_b128 v13, v[152:155] offset:0
  s_waitcnt lgkmcnt(5)
  v_mfma_f32_32x32x16_bf16 v[48:63], v[244:247], v[16:19], v[48:63]
  ds_read_b64_tr_b16 v[240:241], v12 offset:0
  ds_read_b64_tr_b16 v[242:243], v12 offset:256
  v_mfma_f32_32x32x16_bf16 v[64:79], v[244:247], v[20:23], v[64:79]
  ds_read_b128 v[224:227], v11 offset:32768
  ds_read_b128 v[228:231], v11 offset:36864
  v_mfma_f32_32x32x16_bf16 v[80:95], v[244:247], v[24:27], v[80:95]
  ds_read_b128 v[232:235], v11 offset:40960
  ds_read_b128 v[236:239], v11 offset:45056
  v_mfma_f32_32x32x16_bf16 v[96:111], v[244:247], v[28:31], v[96:111]
  s_waitcnt vmcnt(16)
  ds_write_b128 v13, v[156:159] offset:1024
  s_waitcnt lgkmcnt(5)
  v_mfma_f32_32x32x16_bf16 v[48:63], v[240:243], v[32:35], v[48:63]
  ds_read_b64_tr_b16 v[244:245], v12 offset:1024
  ds_read_b64_tr_b16 v[246:247], v12 offset:1280
  v_mfma_f32_32x32x16_bf16 v[64:79], v[240:243], v[36:39], v[64:79]
  ds_read_b128 v[16:19], v8 offset:49152
  ds_read_b128 v[20:23], v8 offset:53248
  v_mfma_f32_32x32x16_bf16 v[80:95], v[240:243], v[40:43], v[80:95]
  ds_read_b128 v[24:27], v8 offset:57344
  ds_read_b128 v[28:31], v8 offset:61440
  v_mfma_f32_32x32x16_bf16 v[96:111], v[240:243], v[44:47], v[96:111]
  s_waitcnt vmcnt(15)
  ds_write_b128 v13, v[160:163] offset:0
  s_waitcnt lgkmcnt(5)
  v_mfma_f32_32x32x16_bf16 v[48:63], v[244:247], v[224:227], v[48:63]
  ds_read_b64_tr_b16 v[240:241], v12 offset:0
  ds_read_b64_tr_b16 v[242:243], v12 offset:256
  v_mfma_f32_32x32x16_bf16 v[64:79], v[244:247], v[228:231], v[64:79]
  ds_read_b128 v[32:35], v9 offset:49152
  ds_read_b128 v[36:39], v9 offset:53248
  v_mfma_f32_32x32x16_bf16 v[80:95], v[244:247], v[232:235], v[80:95]
  ds_read_b128 v[40:43], v9 offset:57344
  ds_read_b128 v[44:47], v9 offset:61440
  v_mfma_f32_32x32x16_bf16 v[96:111], v[244:247], v[236:239], v[96:111]
  s_waitcnt vmcnt(14)
  ds_write_b128 v13, v[164:167] offset:1024
  s_waitcnt lgkmcnt(5)
  v_mfma_f32_32x32x16_bf16 v[48:63], v[240:243], v[16:19], v[48:63]
  ds_read_b64_tr_b16 v[244:245], v12 offset:1024
  ds_read_b64_tr_b16 v[246:247], v12 offset:1280
  v_mfma_f32_32x32x16_bf16 v[64:79], v[240:243], v[20:23], v[64:79]
  ds_read_b128 v[224:227], v10 offset:49152
  ds_read_b128 v[228:231], v10 offset:53248
  v_mfma_f32_32x32x16_bf16 v[80:95], v[240:243], v[24:27], v[80:95]
  ds_read_b128 v[232:235], v10 offset:57344
  ds_read_b128 v[236:239], v10 offset:61440
  v_mfma_f32_32x32x16_bf16 v[96:111], v[240:243], v[28:31], v[96:111]
  s_waitcnt vmcnt(13)
  ds_write_b128 v13, v[168:171] offset:0
  s_waitcnt lgkmcnt(5)
  v_mfma_f32_32x32x16_bf16 v[48:63], v[244:247], v[32:35], v[48:63]
  ds_read_b64_tr_b16 v[240:241], v12 offset:0
  ds_read_b64_tr_b16 v[242:243], v12 offset:256
  v_mfma_f32_32x32x16_bf16 v[64:79], v[244:247], v[36:39], v[64:79]
  ds_read_b128 v[16:19], v11 offset:49152
  ds_read_b128 v[20:23], v11 offset:53248
  v_mfma_f32_32x32x16_bf16 v[80:95], v[244:247], v[40:43], v[80:95]
  ds_read_b128 v[24:27], v11 offset:57344
  ds_read_b128 v[28:31], v11 offset:61440
  v_mfma_f32_32x32x16_bf16 v[96:111], v[244:247], v[44:47], v[96:111]
  s_waitcnt vmcnt(12)
  ds_write_b128 v13, v[172:175] offset:1024
  s_waitcnt lgkmcnt(5)
  v_mfma_f32_32x32x16_bf16 v[48:63], v[240:243], v[224:227], v[48:63]
  ds_read_b64_tr_b16 v[244:245], v12 offset:1024
  ds_read_b64_tr_b16 v[246:247], v12 offset:1280
  v_mfma_f32_32x32x16_bf16 v[64:79], v[240:243], v[228:231], v[64:79]
  v_add_u32 v8, 0x10000, v8
  v_add_u32 v9, 0x10000, v9
  v_add_u32 v10, 0x10000, v10
  v_add_u32 v11, 0x10000, v11
  ds_read_b128 v[32:35], v8 offset:0
  ds_read_b128 v[36:39], v8 offset:4096
  v_mfma_f32_32x32x16_bf16 v[80:95], v[240:243], v[232:235], v[80:95]
  ds_read_b128 v[40:43], v8 offset:8192
  ds_read_b128 v[44:47], v8 offset:12288
  v_mfma_f32_32x32x16_bf16 v[96:111], v[240:243], v[236:239], v[96:111]
  s_waitcnt vmcnt(11)
  ds_write_b128 v13, v[176:179] offset:0
  s_waitcnt lgkmcnt(5)
  v_mfma_f32_32x32x16_bf16 v[48:63], v[244:247], v[16:19], v[48:63]
  ds_read_b64_tr_b16 v[240:241], v12 offset:0
  ds_read_b64_tr_b16 v[242:243], v12 offset:256
  v_mfma_f32_32x32x16_bf16 v[64:79], v[244:247], v[20:23], v[64:79]
  ds_read_b128 v[224:227], v9 offset:0
  ds_read_b128 v[228:231], v9 offset:4096
  v_mfma_f32_32x32x16_bf16 v[80:95], v[244:247], v[24:27], v[80:95]
  ds_read_b128 v[232:235], v9 offset:8192
  ds_read_b128 v[236:239], v9 offset:12288
  v_mfma_f32_32x32x16_bf16 v[96:111], v[244:247], v[28:31], v[96:111]
  s_waitcnt vmcnt(10)
  ds_write_b128 v13, v[180:183] offset:1024
  s_waitcnt lgkmcnt(5)
  v_mfma_f32_32x32x16_bf16 v[48:63], v[240:243], v[32:35], v[48:63]
  ds_read_b64_tr_b16 v[244:245], v12 offset:1024
  ds_read_b64_tr_b16 v[246:247], v12 offset:1280
  v_mfma_f32_32x32x16_bf16 v[64:79], v[240:243], v[36:39], v[64:79]
  ds_read_b128 v[16:19], v10 offset:0
  ds_read_b128 v[20:23], v10 offset:4096
  v_mfma_f32_32x32x16_bf16 v[80:95], v[240:243], v[40:43], v[80:95]
  ds_read_b128 v[24:27], v10 offset:8192
  ds_read_b128 v[28:31], v10 offset:12288
  v_mfma_f32_32x32x16_bf16 v[96:111], v[240:243], v[44:47], v[96:111]
  s_waitcnt vmcnt(9)
  ds_write_b128 v13, v[184:187] offset:0
  s_waitcnt lgkmcnt(5)
  v_mfma_f32_32x32x16_bf16 v[48:63], v[244:247], v[224:227], v[48:63]
  ds_read_b64_tr_b16 v[240:241], v12 offset:0
  ds_read_b64_tr_b16 v[242:243], v12 offset:256
  v_mfma_f32_32x32x16_bf16 v[64:79], v[244:247], v[228:231], v[64:79]
  ds_read_b128 v[32:35], v11 offset:0
  ds_read_b128 v[36:39], v11 offset:4096
  v_mfma_f32_32x32x16_bf16 v[80:95], v[244:247], v[232:235], v[80:95]
  ds_read_b128 v[40:43], v11 offset:8192
  ds_read_b128 v[44:47], v11 offset:12288
  v_mfma_f32_32x32x16_bf16 v[96:111], v[244:247], v[236:239], v[96:111]
  s_waitcnt vmcnt(8)
  ds_write_b128 v13, v[188:191] offset:1024
  s_waitcnt lgkmcnt(5)
  v_mfma_f32_32x32x16_bf16 v[48:63], v[240:243], v[16:19], v[48:63]
  ds_read_b64_tr_b16 v[244:245], v12 offset:1024
  ds_read_b64_tr_b16 v[246:247], v12 offset:1280
  v_mfma_f32_32x32x16_bf16 v[64:79], v[240:243], v[20:23], v[64:79]
  ds_read_b128 v[224:227], v8 offset:16384
  ds_read_b128 v[228:231], v8 offset:20480
  v_mfma_f32_32x32x16_bf16 v[80:95], v[240:243], v[24:27], v[80:95]
  ds_read_b128 v[232:235], v8 offset:24576
  ds_read_b128 v[236:239], v8 offset:28672
  v_mfma_f32_32x32x16_bf16 v[96:111], v[240:243], v[28:31], v[96:111]
  s_waitcnt vmcnt(7)
  ds_write_b128 v13, v[192:195] offset:0
  s_waitcnt lgkmcnt(5)
  v_mfma_f32_32x32x16_bf16 v[48:63], v[244:247], v[32:35], v[48:63]
  ds_read_b64_tr_b16 v[240:241], v12 offset:0
  ds_read_b64_tr_b16 v[242:243], v12 offset:256
  v_mfma_f32_32x32x16_bf16 v[64:79], v[244:247], v[36:39], v[64:79]
  ds_read_b128 v[16:19], v9 offset:16384
  ds_read_b128 v[20:23], v9 offset:20480
  v_mfma_f32_32x32x16_bf16 v[80:95], v[244:247], v[40:43], v[80:95]
  ds_read_b128 v[24:27], v9 offset:24576
  ds_read_b128 v[28:31], v9 offset:28672
  v_mfma_f32_32x32x16_bf16 v[96:111], v[244:247], v[44:47], v[96:111]
  s_waitcnt vmcnt(6)
  ds_write_b128 v13, v[196:199] offset:1024
  s_waitcnt lgkmcnt(5)
  v_mfma_f32_32x32x16_bf16 v[48:63], v[240:243], v[224:227], v[48:63]
  ds_read_b64_tr_b16 v[244:245], v12 offset:1024
  ds_read_b64_tr_b16 v[246:247], v12 offset:1280
  v_mfma_f32_32x32x16_bf16 v[64:79], v[240:243], v[228:231], v[64:79]
  ds_read_b128 v[32:35], v10 offset:16384
  ds_read_b128 v[36:39], v10 offset:20480
  v_mfma_f32_32x32x16_bf16 v[80:95], v[240:243], v[232:235], v[80:95]
  ds_read_b128 v[40:43], v10 offset:24576
  ds_read_b128 v[44:47], v10 offset:28672
  v_mfma_f32_32x32x16_bf16 v[96:111], v[240:243], v[236:239], v[96:111]
  s_waitcnt vmcnt(5)
  ds_write_b128 v13, v[200:203] offset:0
  s_waitcnt lgkmcnt(5)
  v_mfma_f32_32x32x16_bf16 v[48:63], v[244:247], v[16:19], v[48:63]
  ds_read_b64_tr_b16 v[240:241], v12 offset:0
  ds_read_b64_tr_b16 v[242:243], v12 offset:256
  v_mfma_f32_32x32x16_bf16 v[64:79], v[244:247], v[20:23], v[64:79]
  ds_read_b128 v[224:227], v11 offset:16384
  ds_read_b128 v[228:231], v11 offset:20480
  v_mfma_f32_32x32x16_bf16 v[80:95], v[244:247], v[24:27], v[80:95]
  ds_read_b128 v[232:235], v11 offset:24576
  ds_read_b128 v[236:239], v11 offset:28672
  v_mfma_f32_32x32x16_bf16 v[96:111], v[244:247], v[28:31], v[96:111]
  s_waitcnt vmcnt(4)
  ds_write_b128 v13, v[204:207] offset:1024
  s_waitcnt lgkmcnt(5)
  v_mfma_f32_32x32x16_bf16 v[48:63], v[240:243], v[32:35], v[48:63]
  ds_read_b64_tr_b16 v[244:245], v12 offset:1024
  ds_read_b64_tr_b16 v[246:247], v12 offset:1280
  v_mfma_f32_32x32x16_bf16 v[64:79], v[240:243], v[36:39], v[64:79]
  ds_read_b128 v[16:19], v8 offset:32768
  ds_read_b128 v[20:23], v8 offset:36864
  v_mfma_f32_32x32x16_bf16 v[80:95], v[240:243], v[40:43], v[80:95]
  ds_read_b128 v[24:27], v8 offset:40960
  ds_read_b128 v[28:31], v8 offset:45056
  v_mfma_f32_32x32x16_bf16 v[96:111], v[240:243], v[44:47], v[96:111]
  s_waitcnt vmcnt(3)
  ds_write_b128 v13, v[208:211] offset:0
  s_waitcnt lgkmcnt(5)
  v_mfma_f32_32x32x16_bf16 v[48:63], v[244:247], v[224:227], v[48:63]
  ds_read_b64_tr_b16 v[240:241], v12 offset:0
  ds_read_b64_tr_b16 v[242:243], v12 offset:256
  v_mfma_f32_32x32x16_bf16 v[64:79], v[244:247], v[228:231], v[64:79]
  ds_read_b128 v[32:35], v9 offset:32768
  ds_read_b128 v[36:39], v9 offset:36864
  v_mfma_f32_32x32x16_bf16 v[80:95], v[244:247], v[232:235], v[80:95]
  ds_read_b128 v[40:43], v9 offset:40960
  ds_read_b128 v[44:47], v9 offset:45056
  v_mfma_f32_32x32x16_bf16 v[96:111], v[244:247], v[236:239], v[96:111]
  s_waitcnt vmcnt(2)
  ds_write_b128 v13, v[212:215] offset:1024
  s_waitcnt lgkmcnt(5)
  v_mfma_f32_32x32x16_bf16 v[48:63], v[240:243], v[16:19], v[48:63]
  ds_read_b64_tr_b16 v[244:245], v12 offset:1024
  ds_read_b64_tr_b16 v[246:247], v12 offset:1280
  v_mfma_f32_32x32x16_bf16 v[64:79], v[240:243], v[20:23], v[64:79]
  ds_read_b128 v[224:227], v10 offset:32768
  ds_read_b128 v[228:231], v10 offset:36864
  v_mfma_f32_32x32x16_bf16 v[80:95], v[240:243], v[24:27], v[80:95]
  ds_read_b128 v[232:235], v10 offset:40960
  ds_read_b128 v[236:239], v10 offset:45056
  v_mfma_f32_32x32x16_bf16 v[96:111], v[240:243], v[28:31], v[96:111]
  s_waitcnt vmcnt(1)
  ds_write_b128 v13, v[216:219] offset:0
  s_waitcnt lgkmcnt(5)
  v_mfma_f32_32x32x16_bf16 v[48:63], v[244:247], v[32:35], v[48:63]
  ds_read_b64_tr_b16 v[240:241], v12 offset:0
  ds_read_b64_tr_b16 v[242:243], v12 offset:256
  v_mfma_f32_32x32x16_bf16 v[64:79], v[244:247], v[36:39], v[64:79]
  ds_read_b128 v[16:19], v11 offset:32768
  ds_read_b128 v[20:23], v11 offset:36864
  v_mfma_f32_32x32x16_bf16 v[80:95], v[244:247], v[40:43], v[80:95]
  ds_read_b128 v[24:27], v11 offset:40960
  ds_read_b128 v[28:31], v11 offset:45056
  v_mfma_f32_32x32x16_bf16 v[96:111], v[244:247], v[44:47], v[96:111]
  s_waitcnt vmcnt(0)
  ds_write_b128 v13, v[220:223] offset:1024
  s_waitcnt lgkmcnt(5)
  v_mfma_f32_32x32x16_bf16 v[48:63], v[240:243], v[224:227], v[48:63]
  ds_read_b64_tr_b16 v[244:245], v12 offset:1024
  ds_read_b64_tr_b16 v[246:247], v12 offset:1280
  v_mfma_f32_32x32x16_bf16 v[64:79], v[240:243], v[228:231], v[64:79]
  v_mfma_f32_32x32x16_bf16 v[80:95], v[240:243], v[232:235], v[80:95]
  v_mfma_f32_32x32x16_bf16 v[96:111], v[240:243], v[236:239], v[96:111]
  s_waitcnt lgkmcnt(0)
  v_mfma_f32_32x32x16_bf16 v[48:63], v[244:247], v[16:19], v[48:63]
  v_mfma_f32_32x32x16_bf16 v[64:79], v[244:247], v[20:23], v[64:79]
  v_mfma_f32_32x32x16_bf16 v[80:95], v[244:247], v[24:27], v[80:95]
  v_mfma_f32_32x32x16_bf16 v[96:111], v[244:247], v[28:31], v[96:111]
  v_mov_b32 v12, 36892
  s_mov_b32 s14, 0
lw_45:
  ds_read_b32 v13, v12
  s_add_u32 s14, s14, 1
  s_waitcnt lgkmcnt(0)
  v_readfirstlane_b32 s15, v13
  s_cmp_gt_u32 s14, 0x200000
  s_cbranch_scc1 lwe_46
  s_cmp_ge_u32 s15, 4
  s_cbranch_scc1 lwe_46
  s_sleep 1
  s_branch lw_45
lwe_46:
  v_mov_b32 v12, 36864
  v_mov_b32 v13, 1
  s_mov_b64 exec, 1
  ds_add_u32 v12, v13
  s_mov_b64 exec, -1
  v_mov_b32 v232, 0
  buffer_load_dwordx2 v[234:235], v232, s[68:71], 0 offen sc1
  s_mov_b32 s4, 0xbfb8aa3b
  s_mov_b32 s5, 0xbfb8aa3b
  s_mov_b32 s6, 1.0
  s_mov_b32 s7, 1.0
  s_lshl_b32 s3, s72, 2
  s_mul_i32 s3, s3, 56
  s_add_u32 s3, s3, s9
  s_lshl_b32 s3, s3, 11
  s_add_u32 s8, s3, 6291456
  s_lshl_b32 s3, s72, 9
  s_lshl_b32 s10, s9, 3
  s_add_u32 s10, s10, s3
  s_add_u32 s10, s10, 16850944
  v_mul_f32 v16, s4, v48
  v_mul_f32 v17, s4, v49
  v_mul_f32 v18, s4, v50
  v_mul_f32 v19, s4, v51
  v_mul_f32 v20, s4, v52
  v_mul_f32 v21, s4, v53
  v_mul_f32 v22, s4, v54
  v_mul_f32 v23, s4, v55
  v_exp_f32 v16, v16
  v_exp_f32 v17, v17
  v_exp_f32 v18, v18
  v_exp_f32 v19, v19
  v_exp_f32 v20, v20
  v_exp_f32 v21, v21
  v_exp_f32 v22, v22
  v_exp_f32 v23, v23
  v_add_f32 v16, 1.0, v16
  v_add_f32 v17, 1.0, v17
  v_add_f32 v18, 1.0, v18
  v_add_f32 v19, 1.0, v19
  v_add_f32 v20, 1.0, v20
  v_add_f32 v21, 1.0, v21
  v_add_f32 v22, 1.0, v22
  v_add_f32 v23, 1.0, v23
  v_rcp_f32 v16, v16
  v_rcp_f32 v17, v17
  v_rcp_f32 v18, v18
  v_rcp_f32 v19, v19
  v_rcp_f32 v20, v20
  v_rcp_f32 v21, v21
  v_rcp_f32 v22, v22
  v_rcp_f32 v23, v23
  v_mul_f32 v16, v48, v16
  v_mul_f32 v17, v49, v17
  v_mul_f32 v18, v50, v18
  v_mul_f32 v19, v51, v19
  v_mul_f32 v20, v52, v20
  v_mul_f32 v21, v53, v21
  v_mul_f32 v22, v54, v22
  v_mul_f32 v23, v55, v23
  v_cvt_pk_bf16_f32 v112, v16, v17
  v_cvt_pk_bf16_f32 v113, v18, v19
  v_cvt_pk_bf16_f32 v114, v20, v21
  v_cvt_pk_bf16_f32 v115, v22, v23
  v_mul_f32 v16, s4, v56
  v_mul_f32 v17, s4, v57
  v_mul_f32 v18, s4, v58
  v_mul_f32 v19, s4, v59
  v_mul_f32 v20, s4, v60
  v_mul_f32 v21, s4, v61
  v_mul_f32 v22, s4, v62
  v_mul_f32 v23, s4, v63
  v_exp_f32 v16, v16
  v_exp_f32 v17, v17
  v_exp_f32 v18, v18
  v_exp_f32 v19, v19
  v_exp_f32 v20, v20
  v_exp_f32 v21, v21
  v_exp_f32 v22, v22
  v_exp_f32 v23, v23
  v_add_f32 v16, 1.0, v16
  v_add_f32 v17, 1.0, v17
  v_add_f32 v18, 1.0, v18
  v_add_f32 v19, 1.0, v19
  v_add_f32 v20, 1.0, v20
  v_add_f32 v21, 1.0, v21
  v_add_f32 v22, 1.0, v22
  v_add_f32 v23, 1.0, v23
  v_rcp_f32 v16, v16
  v_rcp_f32 v17, v17
  v_rcp_f32 v18, v18
  v_rcp_f32 v19, v19
  v_rcp_f32 v20, v20
  v_rcp_f32 v21, v21
  v_rcp_f32 v22, v22
  v_rcp_f32 v23, v23
  v_mul_f32 v16, v56, v16
  v_mul_f32 v17, v57, v17
  v_mul_f32 v18, v58, v18
  v_mul_f32 v19, v59, v19
  v_mul_f32 v20, v60, v20
  v_mul_f32 v21, v61, v21
  v_mul_f32 v22, v62, v22
  v_mul_f32 v23, v63, v23
  v_cvt_pk_bf16_f32 v116, v16, v17
  v_cvt_pk_bf16_f32 v117, v18, v19
  v_cvt_pk_bf16_f32 v118, v20, v21
  v_cvt_pk_bf16_f32 v119, v22, v23
  v_mul_f32 v16, s4, v64
  v_mul_f32 v17, s4, v65
  v_mul_f32 v18, s4, v66
  v_mul_f32 v19, s4, v67
  v_mul_f32 v20, s4, v68
  v_mul_f32 v21, s4, v69
  v_mul_f32 v22, s4, v70
  v_mul_f32 v23, s4, v71
  v_exp_f32 v16, v16
  v_exp_f32 v17, v17
  v_exp_f32 v18, v18
  v_exp_f32 v19, v19
  v_exp_f32 v20, v20
  v_exp_f32 v21, v21
  v_exp_f32 v22, v22
  v_exp_f32 v23, v23
  v_add_f32 v16, 1.0, v16
  v_add_f32 v17, 1.0, v17
  v_add_f32 v18, 1.0, v18
  v_add_f32 v19, 1.0, v19
  v_add_f32 v20, 1.0, v20
  v_add_f32 v21, 1.0, v21
  v_add_f32 v22, 1.0, v22
  v_add_f32 v23, 1.0, v23
  v_rcp_f32 v16, v16
  v_rcp_f32 v17, v17
  v_rcp_f32 v18, v18
  v_rcp_f32 v19, v19
  v_rcp_f32 v20, v20
  v_rcp_f32 v21, v21
  v_rcp_f32 v22, v22
  v_rcp_f32 v23, v23
  v_mul_f32 v16, v64, v16
  v_mul_f32 v17, v65, v17
  v_mul_f32 v18, v66, v18
  v_mul_f32 v19, v67, v19
  v_mul_f32 v20, v68, v20
  v_mul_f32 v21, v69, v21
  v_mul_f32 v22, v70, v22
  v_mul_f32 v23, v71, v23
  v_cvt_pk_bf16_f32 v120, v16, v17
  v_cvt_pk_bf16_f32 v121, v18, v19
  v_cvt_pk_bf16_f32 v122, v20, v21
  v_cvt_pk_bf16_f32 v123, v22, v23
  v_mul_f32 v16, s4, v72
  v_mul_f32 v17, s4, v73
  v_mul_f32 v18, s4, v74
  v_mul_f32 v19, s4, v75
  v_mul_f32 v20, s4, v76
  v_mul_f32 v21, s4, v77
  v_mul_f32 v22, s4, v78
  v_mul_f32 v23, s4, v79
  v_exp_f32 v16, v16
  v_exp_f32 v17, v17
  v_exp_f32 v18, v18
  v_exp_f32 v19, v19
  v_exp_f32 v20, v20
  v_exp_f32 v21, v21
  v_exp_f32 v22, v22
  v_exp_f32 v23, v23
  v_add_f32 v16, 1.0, v16
  v_add_f32 v17, 1.0, v17
  v_add_f32 v18, 1.0, v18
  v_add_f32 v19, 1.0, v19
  v_add_f32 v20, 1.0, v20
  v_add_f32 v21, 1.0, v21
  v_add_f32 v22, 1.0, v22
  v_add_f32 v23, 1.0, v23
  v_rcp_f32 v16, v16
  v_rcp_f32 v17, v17
  v_rcp_f32 v18, v18
  v_rcp_f32 v19, v19
  v_rcp_f32 v20, v20
  v_rcp_f32 v21, v21
  v_rcp_f32 v22, v22
  v_rcp_f32 v23, v23
  v_mul_f32 v16, v72, v16
  v_mul_f32 v17, v73, v17
  v_mul_f32 v18, v74, v18
  v_mul_f32 v19, v75, v19
  v_mul_f32 v20, v76, v20
  v_mul_f32 v21, v77, v21
  v_mul_f32 v22, v78, v22
  v_mul_f32 v23, v79, v23
  v_cvt_pk_bf16_f32 v124, v16, v17
  v_cvt_pk_bf16_f32 v125, v18, v19
  v_cvt_pk_bf16_f32 v126, v20, v21
  v_cvt_pk_bf16_f32 v127, v22, v23
  v_mul_f32 v16, s4, v80
  v_mul_f32 v17, s4, v81
  v_mul_f32 v18, s4, v82
  v_mul_f32 v19, s4, v83
  v_mul_f32 v20, s4, v84
  v_mul_f32 v21, s4, v85
  v_mul_f32 v22, s4, v86
  v_mul_f32 v23, s4, v87
  v_exp_f32 v16, v16
  v_exp_f32 v17, v17
  v_exp_f32 v18, v18
  v_exp_f32 v19, v19
  v_exp_f32 v20, v20
  v_exp_f32 v21, v21
  v_exp_f32 v22, v22
  v_exp_f32 v23, v23
  v_add_f32 v16, 1.0, v16
  v_add_f32 v17, 1.0, v17
  v_add_f32 v18, 1.0, v18
  v_add_f32 v19, 1.0, v19
  v_add_f32 v20, 1.0, v20
  v_add_f32 v21, 1.0, v21
  v_add_f32 v22, 1.0, v22
  v_add_f32 v23, 1.0, v23
  v_rcp_f32 v16, v16
  v_rcp_f32 v17, v17
  v_rcp_f32 v18, v18
  v_rcp_f32 v19, v19
  v_rcp_f32 v20, v20
  v_rcp_f32 v21, v21
  v_rcp_f32 v22, v22
  v_rcp_f32 v23, v23
  v_mul_f32 v16, v80, v16
  v_mul_f32 v17, v81, v17
  v_mul_f32 v18, v82, v18
  v_mul_f32 v19, v83, v19
  v_mul_f32 v20, v84, v20
  v_mul_f32 v21, v85, v21
  v_mul_f32 v22, v86, v22
  v_mul_f32 v23, v87, v23
  v_cvt_pk_bf16_f32 v128, v16, v17
  v_cvt_pk_bf16_f32 v129, v18, v19
  v_cvt_pk_bf16_f32 v130, v20, v21
  v_cvt_pk_bf16_f32 v131, v22, v23
  v_mul_f32 v16, s4, v88
  v_mul_f32 v17, s4, v89
  v_mul_f32 v18, s4, v90
  v_mul_f32 v19, s4, v91
  v_mul_f32 v20, s4, v92
  v_mul_f32 v21, s4, v93
  v_mul_f32 v22, s4, v94
  v_mul_f32 v23, s4, v95
  v_exp_f32 v16, v16
  v_exp_f32 v17, v17
  v_exp_f32 v18, v18
  v_exp_f32 v19, v19
  v_exp_f32 v20, v20
  v_exp_f32 v21, v21
  v_exp_f32 v22, v22
  v_exp_f32 v23, v23
  v_add_f32 v16, 1.0, v16
  v_add_f32 v17, 1.0, v17
  v_add_f32 v18, 1.0, v18
  v_add_f32 v19, 1.0, v19
  v_add_f32 v20, 1.0, v20
  v_add_f32 v21, 1.0, v21
  v_add_f32 v22, 1.0, v22
  v_add_f32 v23, 1.0, v23
  v_rcp_f32 v16, v16
  v_rcp_f32 v17, v17
  v_rcp_f32 v18, v18
  v_rcp_f32 v19, v19
  v_rcp_f32 v20, v20
  v_rcp_f32 v21, v21
  v_rcp_f32 v22, v22
  v_rcp_f32 v23, v23
  v_mul_f32 v16, v88, v16
  v_mul_f32 v17, v89, v17
  v_mul_f32 v18, v90, v18
  v_mul_f32 v19, v91, v19
  v_mul_f32 v20, v92, v20
  v_mul_f32 v21, v93, v21
  v_mul_f32 v22, v94, v22
  v_mul_f32 v23, v95, v23
  v_cvt_pk_bf16_f32 v132, v16, v17
  v_cvt_pk_bf16_f32 v133, v18, v19
  v_cvt_pk_bf16_f32 v134, v20, v21
  v_cvt_pk_bf16_f32 v135, v22, v23
  v_mul_f32 v16, s4, v96
  v_mul_f32 v17, s4, v97
  v_mul_f32 v18, s4, v98
  v_mul_f32 v19, s4, v99
  v_mul_f32 v20, s4, v100
  v_mul_f32 v21, s4, v101
  v_mul_f32 v22, s4, v102
  v_mul_f32 v23, s4, v103
  v_exp_f32 v16, v16
  v_exp_f32 v17, v17
  v_exp_f32 v18, v18
  v_exp_f32 v19, v19
  v_exp_f32 v20, v20
  v_exp_f32 v21, v21
  v_exp_f32 v22, v22
  v_exp_f32 v23, v23
  v_add_f32 v16, 1.0, v16
  v_add_f32 v17, 1.0, v17
  v_add_f32 v18, 1.0, v18
  v_add_f32 v19, 1.0, v19
  v_add_f32 v20, 1.0, v20
  v_add_f32 v21, 1.0, v21
  v_add_f32 v22, 1.0, v22
  v_add_f32 v23, 1.0, v23
  v_rcp_f32 v16, v16
  v_rcp_f32 v17, v17
  v_rcp_f32 v18, v18
  v_rcp_f32 v19, v19
  v_rcp_f32 v20, v20
  v_rcp_f32 v21, v21
  v_rcp_f32 v22, v22
  v_rcp_f32 v23, v23
  v_mul_f32 v16, v96, v16
  v_mul_f32 v17, v97, v17
  v_mul_f32 v18, v98, v18
  v_mul_f32 v19, v99, v19
  v_mul_f32 v20, v100, v20
  v_mul_f32 v21, v101, v21
  v_mul_f32 v22, v102, v22
  v_mul_f32 v23, v103, v23
  v_cvt_pk_bf16_f32 v136, v16, v17
  v_cvt_pk_bf16_f32 v137, v18, v19
  v_cvt_pk_bf16_f32 v138, v20, v21
  v_cvt_pk_bf16_f32 v139, v22, v23
  v_mul_f32 v16, s4, v104
  v_mul_f32 v17, s4, v105
  v_mul_f32 v18, s4, v106
  v_mul_f32 v19, s4, v107
  v_mul_f32 v20, s4, v108
  v_mul_f32 v21, s4, v109
  v_mul_f32 v22, s4, v110
  v_mul_f32 v23, s4, v111
  v_exp_f32 v16, v16
  v_exp_f32 v17, v17
  v_exp_f32 v18, v18
  v_exp_f32 v19, v19
  v_exp_f32 v20, v20
  v_exp_f32 v21, v21
  v_exp_f32 v22, v22
  v_exp_f32 v23, v23
  v_add_f32 v16, 1.0, v16
  v_add_f32 v17, 1.0, v17
  v_add_f32 v18, 1.0, v18
  v_add_f32 v19, 1.0, v19
  v_add_f32 v20, 1.0, v20
  v_add_f32 v21, 1.0, v21
  v_add_f32 v22, 1.0, v22
  v_add_f32 v23, 1.0, v23
  v_rcp_f32 v16, v16
  v_rcp_f32 v17, v17
  v_rcp_f32 v18, v18
  v_rcp_f32 v19, v19
  v_rcp_f32 v20, v20
  v_rcp_f32 v21, v21
  v_rcp_f32 v22, v22
  v_rcp_f32 v23, v23
  v_mul_f32 v16, v104, v16
  v_mul_f32 v17, v105, v17
  v_mul_f32 v18, v106, v18
  v_mul_f32 v19, v107, v19
  v_mul_f32 v20, v108, v20
  v_mul_f32 v21, v109, v21
  v_mul_f32 v22, v110, v22
  v_mul_f32 v23, v111, v23
  v_cvt_pk_bf16_f32 v140, v16, v17
  v_cvt_pk_bf16_f32 v141, v18, v19
  v_cvt_pk_bf16_f32 v142, v20, v21
  v_cvt_pk_bf16_f32 v143, v22, v23
  s_lshl_b32 s3, s74, 2
  s_add_u32 s3, s3, 36928
  v_mov_b32 v16, s3
  s_mov_b32 s14, 0
lw_47:
  ds_read_b32 v17, v16
  s_add_u32 s14, s14, 1
  s_waitcnt lgkmcnt(0)
  v_readfirstlane_b32 s15, v17
  s_cmp_gt_u32 s14, 0x200000
  s_cbranch_scc1 lwe_48
  s_cmp_ge_u32 s15, 1
  s_cbranch_scc1 lwe_48
  s_sleep 4
  s_branch lw_47
lwe_48:
  buffer_store_dwordx4 v[112:115], v7, s[44:47], s8 offen offset:0 sc1
  buffer_store_dwordx4 v[116:119], v7, s[44:47], s8 offen offset:1024 sc1
  s_add_u32 s8, s8, 114688
  s_waitcnt vmcnt(0)
  buffer_store_dwordx4 v[120:123], v7, s[44:47], s8 offen offset:0 sc1
  buffer_store_dwordx4 v[124:127], v7, s[44:47], s8 offen offset:1024 sc1
  s_add_u32 s8, s8, 114688
  s_waitcnt vmcnt(0)
  buffer_store_dwordx4 v[128:131], v7, s[44:47], s8 offen offset:0 sc1
  buffer_store_dwordx4 v[132:135], v7, s[44:47], s8 offen offset:1024 sc1
  s_add_u32 s8, s8, 114688
  s_waitcnt vmcnt(0)
  buffer_store_dwordx4 v[136:139], v7, s[44:47], s8 offen offset:0 sc1
  buffer_store_dwordx4 v[140:143], v7, s[44:47], s8 offen offset:1024 sc1
  s_add_u32 s8, s8, 114688
  s_waitcnt vmcnt(0)
  s_mov_b32 s14, 0
ng_49:
  s_waitcnt vmcnt(0)
  v_readfirstlane_b32 s12, v234
  v_readfirstlane_b32 s13, v235
  s_add_u32 s14, s14, 1
  s_cmp_gt_u32 s14, 0x40000
  s_cbranch_scc1 nge_50
  s_cmp_lg_u32 s12, 0
  s_cbranch_scc1 nge_50
  buffer_load_dwordx2 v[234:235], v232, s[68:71], 0 offen sc1
  s_branch ng_49
nge_50:
  v_mov_b32 v16, s12
  v_mov_b32 v17, s13
  v_mov_b32 v18, 0
  s_mov_b64 exec, 1
  buffer_store_dwordx2 v[16:17], v18, s[44:47], s10 offen sc1
  s_mov_b64 exec, -1
  s_branch k_ffn2
k_gate:
  s_cmp_eq_u32 s73, 15
  s_cbranch_scc1 k_f15
  v_lshlrev_b32 v14, 4, v3
  s_mov_b32 s64, s28
  s_mov_b32 s65, s29
  s_mov_b32 s66, 896
  s_mov_b32 s67, 0x00020000
  s_lshl_b32 s10, s11, 7
  buffer_load_dwordx4 v[112:115], v14, s[64:67], s10 offen offset:0
  buffer_load_dwordx4 v[116:119], v14, s[64:67], s10 offen offset:32
  buffer_load_dwordx4 v[120:123], v14, s[64:67], s10 offen offset:64
  buffer_load_dwordx4 v[124:127], v14, s[64:67], s10 offen offset:96
  s_add_u32 s11, s11, 1
  s_cmp_eq_u32 s11, 7
  s_cselect_b32 s11, 0, s11
  s_lshl_b32 s10, s11, 7
  buffer_load_dwordx4 v[128:131], v14, s[64:67], s10 offen offset:0
  buffer_load_dwordx4 v[132:135], v14, s[64:67], s10 offen offset:32
  buffer_load_dwordx4 v[136:139], v14, s[64:67], s10 offen offset:64
  buffer_load_dwordx4 v[140:143], v14, s[64:67], s10 offen offset:96
  s_add_u32 s11, s11, 1
  s_cmp_eq_u32 s11, 7
  s_cselect_b32 s11, 0, s11
  s_lshl_b32 s10, s11, 7
  buffer_load_dwordx4 v[144:147], v14, s[64:67], s10 offen offset:0
  buffer_load_dwordx4 v[148:151], v14, s[64:67], s10 offen offset:32
  buffer_load_dwordx4 v[152:155], v14, s[64:67], s10 offen offset:64
  buffer_load_dwordx4 v[156:159], v14, s[64:67], s10 offen offset:96
  s_add_u32 s11, s11, 1
  s_cmp_eq_u32 s11, 7
  s_cselect_b32 s11, 0, s11
  s_lshl_b32 s10, s11, 7
  buffer_load_dwordx4 v[160:163], v14, s[64:67], s10 offen offset:0
  buffer_load_dwordx4 v[164:167], v14, s[64:67], s10 offen offset:32
  buffer_load_dwordx4 v[168:171], v14, s[64:67], s10 offen offset:64
  buffer_load_dwordx4 v[172:175], v14, s[64:67], s10 offen offset:96
  s_add_u32 s11, s11, 1
  s_cmp_eq_u32 s11, 7
  s_cselect_b32 s11, 0, s11
  s_lshl_b32 s10, s11, 7
  buffer_load_dwordx4 v[176:179], v14, s[64:67], s10 offen offset:0
  buffer_load_dwordx4 v[180:183], v14, s[64:67], s10 offen offset:32
  buffer_load_dwordx4 v[184:187], v14, s[64:67], s10 offen offset:64
  buffer_load_dwordx4 v[188:191], v14, s[64:67], s10 offen offset:96
  s_add_u32 s11, s11, 1
  s_cmp_eq_u32 s11, 7
  s_cselect_b32 s11, 0, s11
  s_lshl_b32 s10, s11, 7
  buffer_load_dwordx4 v[192:195], v14, s[64:67], s10 offen offset:0
  buffer_load_dwordx4 v[196:199], v14, s[64:67], s10 offen offset:32
  buffer_load_dwordx4 v[200:203], v14, s[64:67], s10 offen offset:64
  buffer_load_dwordx4 v[204:207], v14, s[64:67], s10 offen offset:96
  s_add_u32 s11, s11, 1
  s_cmp_eq_u32 s11, 7
  s_cselect_b32 s11, 0, s11
  s_lshl_b32 s10, s11, 7
  buffer_load_dwordx4 v[208:211], v14, s[64:67], s10 offen offset:0
  buffer_load_dwordx4 v[212:215], v14, s[64:67], s10 offen offset:32
  buffer_load_dwordx4 v[216:219], v14, s[64:67], s10 offen offset:64
  buffer_load_dwordx4 v[220:223], v14, s[64:67], s10 offen offset:96
  s_add_u32 s11, s11, 1
  s_cmp_eq_u32 s11, 7
  s_cselect_b32 s11, 0, s11
  s_lshl_b32 s3, s74, 12
  s_add_u32 s3, s3, 49152
  v_add_u32 v8, s3, v8
  v_add_u32 v9, s3, v9
  v_add_u32 v10, s3, v10
  v_add_u32 v11, s3, v11
  v_mov_b32 v16, 0
  v_mov_b32 v17, 0
  v_mov_b32 v18, 0
  v_mov_b32 v19, 0
  s_nop 1
  v_mfma_f32_32x32x16_bf16 v[48:63], v[16:19], v[16:19], 0
  s_waitcnt lgkmcnt(0)
  s_barrier
  s_waitcnt vmcnt(0)
  v_mov_b32 v232, 0
  buffer_load_dwordx2 v[234:235], v232, s[68:71], 0 offen sc1
  v_mov_b32 v1, 36908
  s_mov_b32 s14, 0
lw_51:
  ds_read_b32 v15, v1
  s_add_u32 s14, s14, 1
  s_waitcnt lgkmcnt(0)
  v_readfirstlane_b32 s15, v15
  s_cmp_gt_u32 s14, 0x200000
  s_cbranch_scc1 lwe_52
  s_cmp_ge_u32 s15, 4
  s_cbranch_scc1 lwe_52
  s_sleep 1
  s_branch lw_51
lwe_52:
  ds_read_b128 v[64:67], v8
  v_add_u32 v8, 0x4000, v8
  ds_read_b128 v[68:71], v9
  v_add_u32 v9, 0x4000, v9
  ds_read_b128 v[72:75], v10
  v_add_u32 v10, 0x4000, v10
  ds_read_b128 v[76:79], v11
  v_add_u32 v11, 0x4000, v11
  s_waitcnt lgkmcnt(3)
  v_mfma_f32_32x32x16_bf16 v[48:63], v[112:115], v[64:67], v[48:63]
  s_waitcnt lgkmcnt(2)
  v_mfma_f32_32x32x16_bf16 v[48:63], v[116:119], v[68:71], v[48:63]
  s_waitcnt lgkmcnt(1)
  v_mfma_f32_32x32x16_bf16 v[48:63], v[120:123], v[72:75], v[48:63]
  s_waitcnt lgkmcnt(0)
  v_mfma_f32_32x32x16_bf16 v[48:63], v[124:127], v[76:79], v[48:63]
  v_mov_b32 v1, 36908
  s_mov_b32 s14, 0
lw_53:
  ds_read_b32 v15, v1
  s_add_u32 s14, s14, 1
  s_waitcnt lgkmcnt(0)
  v_readfirstlane_b32 s15, v15
  s_cmp_gt_u32 s14, 0x200000
  s_cbranch_scc1 lwe_54
  s_cmp_ge_u32 s15, 8
  s_cbranch_scc1 lwe_54
  s_sleep 1
  s_branch lw_53
lwe_54:
  ds_read_b128 v[64:67], v8
  v_add_u32 v8, 0x4000, v8
  ds_read_b128 v[68:71], v9
  v_add_u32 v9, 0x4000, v9
  ds_read_b128 v[72:75], v10
  v_add_u32 v10, 0x4000, v10
  ds_read_b128 v[76:79], v11
  v_add_u32 v11, 0x4000, v11
  s_waitcnt lgkmcnt(3)
  v_mfma_f32_32x32x16_bf16 v[48:63], v[128:131], v[64:67], v[48:63]
  s_waitcnt lgkmcnt(2)
  v_mfma_f32_32x32x16_bf16 v[48:63], v[132:135], v[68:71], v[48:63]
  s_waitcnt lgkmcnt(1)
  v_mfma_f32_32x32x16_bf16 v[48:63], v[136:139], v[72:75], v[48:63]
  s_waitcnt lgkmcnt(0)
  v_mfma_f32_32x32x16_bf16 v[48:63], v[140:143], v[76:79], v[48:63]
  v_mov_b32 v1, 36908
  s_mov_b32 s14, 0
lw_55:
  ds_read_b32 v15, v1
  s_add_u32 s14, s14, 1
  s_waitcnt lgkmcnt(0)
  v_readfirstlane_b32 s15, v15
  s_cmp_gt_u32 s14, 0x200000
  s_cbranch_scc1 lwe_56
  s_cmp_ge_u32 s15, 12
  s_cbranch_scc1 lwe_56
  s_sleep 1
  s_branch lw_55
lwe_56:
  ds_read_b128 v[64:67], v8
  v_add_u32 v8, 0x4000, v8
  ds_read_b128 v[68:71], v9
  v_add_u32 v9, 0x4000, v9
  ds_read_b128 v[72:75], v10
  v_add_u32 v10, 0x4000, v10
  ds_read_b128 v[76:79], v11
  v_add_u32 v11, 0x4000, v11
  s_waitcnt lgkmcnt(3)
  v_mfma_f32_32x32x16_bf16 v[48:63], v[144:147], v[64:67], v[48:63]
  s_waitcnt lgkmcnt(2)
  v_mfma_f32_32x32x16_bf16 v[48:63], v[148:151], v[68:71], v[48:63]
  s_waitcnt lgkmcnt(1)
  v_mfma_f32_32x32x16_bf16 v[48:63], v[152:155], v[72:75], v[48:63]
  s_waitcnt lgkmcnt(0)
  v_mfma_f32_32x32x16_bf16 v[48:63], v[156:159], v[76:79], v[48:63]
  v_mov_b32 v1, 36908
  s_mov_b32 s14, 0
lw_57:
  ds_read_b32 v15, v1
  s_add_u32 s14, s14, 1
  s_waitcnt lgkmcnt(0)
  v_readfirstlane_b32 s15, v15
  s_cmp_gt_u32 s14, 0x200000
  s_cbranch_scc1 lwe_58
  s_cmp_ge_u32 s15, 16
  s_cbranch_scc1 lwe_58
  s_sleep 1
  s_branch lw_57
lwe_58:
  ds_read_b128 v[64:67], v8
  v_add_u32 v8, 0x4000, v8
  ds_read_b128 v[68:71], v9
  v_add_u32 v9, 0x4000, v9
  ds_read_b128 v[72:75], v10
  v_add_u32 v10, 0x4000, v10
  ds_read_b128 v[76:79], v11
  v_add_u32 v11, 0x4000, v11
  s_waitcnt lgkmcnt(3)
  v_mfma_f32_32x32x16_bf16 v[48:63], v[160:163], v[64:67], v[48:63]
  s_waitcnt lgkmcnt(2)
  v_mfma_f32_32x32x16_bf16 v[48:63], v[164:167], v[68:71], v[48:63]
  s_waitcnt lgkmcnt(1)
  v_mfma_f32_32x32x16_bf16 v[48:63], v[168:171], v[72:75], v[48:63]
  s_waitcnt lgkmcnt(0)
  v_mfma_f32_32x32x16_bf16 v[48:63], v[172:175], v[76:79], v[48:63]
  v_mov_b32 v1, 36908
  s_mov_b32 s14, 0
lw_59:
  ds_read_b32 v15, v1
  s_add_u32 s14, s14, 1
  s_waitcnt lgkmcnt(0)
  v_readfirstlane_b32 s15, v15
  s_cmp_gt_u32 s14, 0x200000
  s_cbranch_scc1 lwe_60
  s_cmp_ge_u32 s15, 20
  s_cbranch_scc1 lwe_60
  s_sleep 1
  s_branch lw_59
lwe_60:
  ds_read_b128 v[64:67], v8
  v_add_u32 v8, 0x4000, v8
  ds_read_b128 v[68:71], v9
  v_add_u32 v9, 0x4000, v9
  ds_read_b128 v[72:75], v10
  v_add_u32 v10, 0x4000, v10
  ds_read_b128 v[76:79], v11
  v_add_u32 v11, 0x4000, v11
  s_waitcnt lgkmcnt(3)
  v_mfma_f32_32x32x16_bf16 v[48:63], v[176:179], v[64:67], v[48:63]
  s_waitcnt lgkmcnt(2)
  v_mfma_f32_32x32x16_bf16 v[48:63], v[180:183], v[68:71], v[48:63]
  s_waitcnt lgkmcnt(1)
  v_mfma_f32_32x32x16_bf16 v[48:63], v[184:187], v[72:75], v[48:63]
  s_waitcnt lgkmcnt(0)
  v_mfma_f32_32x32x16_bf16 v[48:63], v[188:191], v[76:79], v[48:63]
  v_mov_b32 v1, 36908
  s_mov_b32 s14, 0
lw_61:
  ds_read_b32 v15, v1
  s_add_u32 s14, s14, 1
  s_waitcnt lgkmcnt(0)
  v_readfirstlane_b32 s15, v15
  s_cmp_gt_u32 s14, 0x200000
  s_cbranch_scc1 lwe_62
  s_cmp_ge_u32 s15, 24
  s_cbranch_scc1 lwe_62
  s_sleep 1
  s_branch lw_61
lwe_62:
  ds_read_b128 v[64:67], v8
  v_add_u32 v8, 0x4000, v8
  ds_read_b128 v[68:71], v9
  v_add_u32 v9, 0x4000, v9
  ds_read_b128 v[72:75], v10
  v_add_u32 v10, 0x4000, v10
  ds_read_b128 v[76:79], v11
  v_add_u32 v11, 0x4000, v11
  s_waitcnt lgkmcnt(3)
  v_mfma_f32_32x32x16_bf16 v[48:63], v[192:195], v[64:67], v[48:63]
  s_waitcnt lgkmcnt(2)
  v_mfma_f32_32x32x16_bf16 v[48:63], v[196:199], v[68:71], v[48:63]
  s_waitcnt lgkmcnt(1)
  v_mfma_f32_32x32x16_bf16 v[48:63], v[200:203], v[72:75], v[48:63]
  s_waitcnt lgkmcnt(0)
  v_mfma_f32_32x32x16_bf16 v[48:63], v[204:207], v[76:79], v[48:63]
  v_mov_b32 v1, 36908
  s_mov_b32 s14, 0
lw_63:
  ds_read_b32 v15, v1
  s_add_u32 s14, s14, 1
  s_waitcnt lgkmcnt(0)
  v_readfirstlane_b32 s15, v15
  s_cmp_gt_u32 s14, 0x200000
  s_cbranch_scc1 lwe_64
  s_cmp_ge_u32 s15, 28
  s_cbranch_scc1 lwe_64
  s_sleep 1
  s_branch lw_63
lwe_64:
  ds_read_b128 v[64:67], v8
  v_add_u32 v8, 0x4000, v8
  ds_read_b128 v[68:71], v9
  v_add_u32 v9, 0x4000, v9
  ds_read_b128 v[72:75], v10
  v_add_u32 v10, 0x4000, v10
  ds_read_b128 v[76:79], v11
  v_add_u32 v11, 0x4000, v11
  s_waitcnt lgkmcnt(3)
  v_mfma_f32_32x32x16_bf16 v[48:63], v[208:211], v[64:67], v[48:63]
  s_waitcnt lgkmcnt(2)
  v_mfma_f32_32x32x16_bf16 v[48:63], v[212:215], v[68:71], v[48:63]
  s_waitcnt lgkmcnt(1)
  v_mfma_f32_32x32x16_bf16 v[48:63], v[216:219], v[72:75], v[48:63]
  s_waitcnt lgkmcnt(0)
  v_mfma_f32_32x32x16_bf16 v[48:63], v[220:223], v[76:79], v[48:63]
  s_lshl_b32 s3, s72, 9
  s_lshl_b32 s4, s74, 7
  s_add_u32 s4, s3, s4
  s_add_u32 s4, s4, 16777216
  s_lshl_b32 s10, s74, 3
  s_add_u32 s10, s10, s3
  s_add_u32 s10, s10, 16851392
  v_lshlrev_b32 v13, 2, v2
  s_nop 7
  v_mul_f32 v14, 0xbfb8aa3b, v48
  v_exp_f32 v14, v14
  s_nop 0
  v_add_f32 v14, 1.0, v14
  v_rcp_f32 v14, v14
  s_nop 0
  buffer_store_dword v14, v13, s[44:47], s4 offen sc1
  s_mov_b32 s14, 0
ng_65:
  s_waitcnt vmcnt(0)
  v_readfirstlane_b32 s12, v234
  v_readfirstlane_b32 s13, v235
  s_add_u32 s14, s14, 1
  s_cmp_gt_u32 s14, 0x40000
  s_cbranch_scc1 nge_66
  s_cmp_lg_u32 s12, 0
  s_cbranch_scc1 nge_66
  buffer_load_dwordx2 v[234:235], v232, s[68:71], 0 offen sc1
  s_branch ng_65
nge_66:
  v_mov_b32 v16, s12
  v_mov_b32 v17, s13
  v_mov_b32 v18, 0
  s_mov_b64 exec, 1
  buffer_store_dwordx2 v[16:17], v18, s[44:47], s10 offen sc1
  s_mov_b64 exec, -1
  v_mov_b32 v1, 36892
  s_mov_b32 s14, 0
lw_67:
  ds_read_b32 v15, v1
  s_add_u32 s14, s14, 1
  s_waitcnt lgkmcnt(0)
  v_readfirstlane_b32 s15, v15
  s_cmp_gt_u32 s14, 0x200000
  s_cbranch_scc1 lwe_68
  s_cmp_ge_u32 s15, 4
  s_cbranch_scc1 lwe_68
  s_sleep 1
  s_branch lw_67
lwe_68:
  v_mov_b32 v12, 36864
  v_mov_b32 v13, 1
  s_mov_b64 exec, 1
  ds_add_u32 v12, v13
  s_mov_b64 exec, -1
  s_branch k_ffn2
k_f15:
  s_waitcnt lgkmcnt(0)
  s_barrier
  v_mov_b32 v12, 36892
  s_mov_b32 s14, 0
lw_69:
  ds_read_b32 v13, v12
  s_add_u32 s14, s14, 1
  s_waitcnt lgkmcnt(0)
  v_readfirstlane_b32 s15, v13
  s_cmp_gt_u32 s14, 0x200000
  s_cbranch_scc1 lwe_70
  s_cmp_ge_u32 s15, 4
  s_cbranch_scc1 lwe_70
  s_sleep 1
  s_branch lw_69
lwe_70:
  v_mov_b32 v12, 36864
  v_mov_b32 v13, 1
  s_mov_b64 exec, 1
  ds_add_u32 v12, v13
  s_mov_b64 exec, -1
  v_mov_b32 v232, 0
  buffer_load_dwordx2 v[234:235], v232, s[68:71], 0 offen sc1
  s_mov_b32 s14, 0
ng_71:
  s_waitcnt vmcnt(0)
  v_readfirstlane_b32 s12, v234
  v_readfirstlane_b32 s13, v235
  s_add_u32 s14, s14, 1
  s_cmp_gt_u32 s14, 0x40000
  s_cbranch_scc1 nge_72
  s_cmp_lg_u32 s12, 0
  s_cbranch_scc1 nge_72
  buffer_load_dwordx2 v[234:235], v232, s[68:71], 0 offen sc1
  s_branch ng_71
nge_72:
k_ffn2:
  s_mov_b32 s52, s26
  s_mov_b32 s53, s27
  s_mov_b32 s54, 1605632
  s_mov_b32 s55, 0x00020000
  s_mov_b32 s56, s20
  s_mov_b32 s57, s21
  s_mov_b32 s58, 401408
  s_mov_b32 s59, 0x00020000
  s_lshl_b32 s3, s76, 2
  s_add_u32 s3, s3, s74
  s_mul_i32 s5, s3, 3200
  s_mul_i32 s4, s3, 12544
  v_lshlrev_b32 v28, 7, v0
  v_add_u32 v29, 8192, v28
  v_cmp_gt_u32 vcc, 34, v0
  v_bfrev_b32 v15, 1
  v_mov_b32 v30, v28
  v_cndmask_b32 v29, v15, v29, vcc
  v_cmp_gt_u32 vcc, 25, v0
  s_nop 1
  v_cndmask_b32 v30, v15, v30, vcc
  s_lshl_b32 s10, s74, 2
  s_add_u32 s10, s10, 36928
  v_mov_b32 v80, s10
  s_mov_b32 s14, 0
lw_73:
  ds_read_b32 v81, v80
  s_add_u32 s14, s14, 1
  s_waitcnt lgkmcnt(0)
  v_readfirstlane_b32 s15, v81
  s_cmp_gt_u32 s14, 0x200000
  s_cbranch_scc1 lwe_74
  s_cmp_ge_u32 s15, 2
  s_cbranch_scc1 lwe_74
  s_sleep 4
  s_branch lw_73
lwe_74:
  buffer_load_dword v240, v28, s[52:55], s4 offen
  s_waitcnt vmcnt(0)
  buffer_load_dword v241, v29, s[52:55], s4 offen
  buffer_load_dword v242, v30, s[56:59], s5 offen
  s_waitcnt vmcnt(0)
  s_cmp_ge_u32 s76, 28
  s_cbranch_scc1 k_f_done
  s_mul_i32 s3, s76, 37
  s_lshr_b32 s3, s3, 8
  s_mul_i32 s79, s3, 7
  s_sub_u32 s5, s76, s79
  s_lshl_b32 s4, s75, 2
  s_add_u32 s4, s4, s3
  s_mov_b32 s60, s30
  s_mov_b32 s61, s31
  s_mov_b32 s62, 1835008
  s_mov_b32 s63, 0x00020000
  v_lshrrev_b32 v1, 3, v0
  v_mul_u32_u24 v1, 896, v1
  v_bfe_u32 v12, v0, 2, 1
  v_xor_b32 v12, v12, v5
  v_lshl_add_u32 v1, v12, 6, v1
  v_lshl_add_u32 v8, v6, 4, v1
  v_add_u32 v9, 6144, v8
  v_add_u32 v10, 12288, v8
  v_add_u32 v11, 18432, v8
  s_mul_i32 s6, s74, 24576
  s_add_u32 s6, s6, 40960
  v_lshl_add_u32 v1, v3, 2, v4
  v_lshlrev_b32 v1, 7, v1
  v_lshl_add_u32 v1, v5, 5, v1
  v_lshl_add_u32 v1, v6, 3, v1
  v_add_u32 v1, s6, v1
  v_bfe_u32 v13, v0, 3, 1
  v_lshl_add_u32 v14, v13, 6, v1
  v_xor_b32 v13, 1, v13
  v_lshl_add_u32 v15, v13, 6, v1
  s_mul_i32 s7, s74, 401408
  s_lshl_b32 s3, s5, 7
  s_add_u32 s7, s7, s3
  s_mul_i32 s3, s4, 112
  s_mul_i32 s79, s74, 14
  s_add_u32 s3, s3, s79
  s_lshl_b32 s3, s3, 11
  s_add_u32 s8, s3, 6291456
  s_add_u32 s9, s8, 114688
  s_mov_b32 s11, s6
  s_and_b32 s3, s4, 1
  s_lshl_b32 s3, s3, 4
  v_lshlrev_b32 v1, 4, v0
  v_add_u32 v13, s3, v1
  v_cmp_gt_u32 vcc, 28, v0
  s_lshr_b32 s3, s4, 1
  s_lshl_b32 s3, s3, 9
  v_cndmask_b32 v1, v13, v1, vcc
  s_add_u32 s10, s3, 16850944
  v_mul_u32_u24 v4, 7, v0
  v_add_u32 v4, s5, v4
  v_cmp_le_u32 vcc, 224, v4
  v_lshlrev_b32 v4, 7, v4
  v_add_u32 v5, 86016, v4
  v_lshlrev_b32 v6, 2, v2
  v_cndmask_b32 v4, v4, v5, vcc
  v_mov_b32 v80, 0
  v_mov_b32 v81, 0
  v_mov_b32 v82, 0
  v_mov_b32 v83, 0
  s_nop 1
  v_mfma_f32_32x32x16_bf16 v[16:31], v[80:83], v[80:83], 0
  v_mfma_f32_32x32x16_bf16 v[32:47], v[80:83], v[80:83], 0
  v_mfma_f32_32x32x16_bf16 v[48:63], v[80:83], v[80:83], 0
  v_mfma_f32_32x32x16_bf16 v[64:79], v[80:83], v[80:83], 0
  v_mov_b32 v80, 36864
  s_mov_b32 s14, 0
lw_75:
  ds_read_b32 v81, v80
  s_add_u32 s14, s14, 1
  s_waitcnt lgkmcnt(0)
  v_readfirstlane_b32 s15, v81
  s_cmp_gt_u32 s14, 0x200000
  s_cbranch_scc1 lwe_76
  s_cmp_ge_u32 s15, 4
  s_cbranch_scc1 lwe_76
  s_sleep 1
  s_branch lw_75
lwe_76:
  s_mul_i32 s15, s74, 100352
  s_lshl_b32 s3, s5, 7
  s_add_u32 s15, s15, s3
  s_add_u32 m0, s6, 0
  s_nop 0
  buffer_load_dwordx4 v8, s[56:59], s15 offen offset:0 lds
  buffer_load_dwordx4 v9, s[56:59], s15 offen offset:1024 lds
  buffer_load_dwordx4 v10, s[56:59], s15 offen offset:2048 lds
  buffer_load_dwordx4 v11, s[56:59], s15 offen offset:3072 lds
  s_add_u32 s15, s15, 25088
  s_add_u32 m0, s6, 4096
  s_nop 0
  buffer_load_dwordx4 v8, s[56:59], s15 offen offset:0 lds
  buffer_load_dwordx4 v9, s[56:59], s15 offen offset:1024 lds
  buffer_load_dwordx4 v10, s[56:59], s15 offen offset:2048 lds
  buffer_load_dwordx4 v11, s[56:59], s15 offen offset:3072 lds
  s_add_u32 s15, s15, 25088
  s_add_u32 m0, s6, 8192
  s_nop 0
  buffer_load_dwordx4 v8, s[56:59], s15 offen offset:0 lds
  buffer_load_dwordx4 v9, s[56:59], s15 offen offset:1024 lds
  buffer_load_dwordx4 v10, s[56:59], s15 offen offset:2048 lds
  buffer_load_dwordx4 v11, s[56:59], s15 offen offset:3072 lds
  s_add_u32 s15, s15, 25088
  s_add_u32 m0, s6, 12288
  s_nop 0
  buffer_load_dwordx4 v8, s[56:59], s15 offen offset:0 lds
  buffer_load_dwordx4 v9, s[56:59], s15 offen offset:1024 lds
  buffer_load_dwordx4 v10, s[56:59], s15 offen offset:2048 lds
  buffer_load_dwordx4 v11, s[56:59], s15 offen offset:3072 lds
  s_add_u32 s15, s15, 25088
  s_waitcnt vmcnt(12)
  ds_read_b64_tr_b16 v[176:177], v14 offset:0
  ds_read_b64_tr_b16 v[178:179], v14 offset:1024
  ds_read_b64_tr_b16 v[180:181], v15 offset:0
  ds_read_b64_tr_b16 v[182:183], v15 offset:1024
  ds_read_b64_tr_b16 v[184:185], v14 offset:2048
  ds_read_b64_tr_b16 v[186:187], v14 offset:3072
  ds_read_b64_tr_b16 v[188:189], v15 offset:2048
  ds_read_b64_tr_b16 v[190:191], v15 offset:3072
  s_waitcnt lgkmcnt(4)
  s_waitcnt vmcnt(8)
  ds_read_b64_tr_b16 v[192:193], v14 offset:4096
  ds_read_b64_tr_b16 v[194:195], v14 offset:5120
  ds_read_b64_tr_b16 v[196:197], v15 offset:4096
  ds_read_b64_tr_b16 v[198:199], v15 offset:5120
  ds_read_b64_tr_b16 v[200:201], v14 offset:6144
  ds_read_b64_tr_b16 v[202:203], v14 offset:7168
  ds_read_b64_tr_b16 v[204:205], v15 offset:6144
  ds_read_b64_tr_b16 v[206:207], v15 offset:7168
  s_waitcnt lgkmcnt(4)
  s_waitcnt vmcnt(4)
  ds_read_b64_tr_b16 v[208:209], v14 offset:8192
  ds_read_b64_tr_b16 v[210:211], v14 offset:9216
  ds_read_b64_tr_b16 v[212:213], v15 offset:8192
  ds_read_b64_tr_b16 v[214:215], v15 offset:9216
  ds_read_b64_tr_b16 v[216:217], v14 offset:10240
  ds_read_b64_tr_b16 v[218:219], v14 offset:11264
  ds_read_b64_tr_b16 v[220:221], v15 offset:10240
  ds_read_b64_tr_b16 v[222:223], v15 offset:11264
  s_waitcnt lgkmcnt(4)
  s_waitcnt vmcnt(0)
  ds_read_b64_tr_b16 v[224:225], v14 offset:12288
  ds_read_b64_tr_b16 v[226:227], v14 offset:13312
  ds_read_b64_tr_b16 v[228:229], v15 offset:12288
  ds_read_b64_tr_b16 v[230:231], v15 offset:13312
  ds_read_b64_tr_b16 v[232:233], v14 offset:14336
  ds_read_b64_tr_b16 v[234:235], v14 offset:15360
  ds_read_b64_tr_b16 v[236:237], v15 offset:14336
  ds_read_b64_tr_b16 v[238:239], v15 offset:15360
  s_waitcnt lgkmcnt(4)
  s_waitcnt lgkmcnt(0)
  s_add_u32 m0, s6, 0
  s_nop 0
  buffer_load_dwordx4 v8, s[52:55], s7 offen lds
  buffer_load_dwordx4 v9, s[52:55], s7 offen offset:1024 lds
  buffer_load_dwordx4 v10, s[52:55], s7 offen offset:2048 lds
  buffer_load_dwordx4 v11, s[52:55], s7 offen offset:3072 lds
  s_add_u32 s7, s7, 28672
  s_add_u32 m0, s6, 4096
  s_nop 0
  buffer_load_dwordx4 v8, s[52:55], s7 offen lds
  buffer_load_dwordx4 v9, s[52:55], s7 offen offset:1024 lds
  buffer_load_dwordx4 v10, s[52:55], s7 offen offset:2048 lds
  buffer_load_dwordx4 v11, s[52:55], s7 offen offset:3072 lds
  s_add_u32 s7, s7, 28672
  s_add_u32 m0, s6, 8192
  s_nop 0
  buffer_load_dwordx4 v8, s[52:55], s7 offen lds
  buffer_load_dwordx4 v9, s[52:55], s7 offen offset:1024 lds
  buffer_load_dwordx4 v10, s[52:55], s7 offen offset:2048 lds
  buffer_load_dwordx4 v11, s[52:55], s7 offen offset:3072 lds
  s_add_u32 s7, s7, 28672
  s_cmp_lg_u32 s74, 0
  s_cbranch_scc1 k_f_w
  s_mov_b32 exec_lo, 0x1fffffff
  s_mov_b32 exec_hi, 0x0
  s_mov_b32 s14, 0
pl_77:
  buffer_load_dwordx4 v[80:83], v1, s[44:47], s10 offen sc1
  s_add_u32 s14, s14, 1
  s_waitcnt vmcnt(0)
  v_cmp_eq_u64 vcc, s[12:13], v[80:81]
  v_cmp_eq_u64 s[78:79], s[12:13], v[82:83]
  s_cmp_gt_u32 s14, 0x40000
  s_cbranch_scc1 ple_78
  s_and_b64 vcc, vcc, s[78:79]
  s_cmp_eq_u64 vcc, exec
  s_cbranch_scc1 ple_78
  s_sleep 3
  s_branch pl_77
ple_78:
  s_mov_b64 exec, -1
  v_mov_b32 v80, 36900
  v_mov_b32 v81, 1
  s_mov_b64 exec, 1
  ds_add_u32 v80, v81
  s_mov_b64 exec, -1
  s_branch k_f_go
k_f_w:
  v_mov_b32 v80, 36900
  s_mov_b32 s14, 0
lw_79:
  ds_read_b32 v81, v80
  s_add_u32 s14, s14, 1
  s_waitcnt lgkmcnt(0)
  v_readfirstlane_b32 s15, v81
  s_cmp_gt_u32 s14, 0x200000
  s_cbranch_scc1 lwe_80
  s_cmp_ge_u32 s15, 1
  s_cbranch_scc1 lwe_80
  s_sleep 2
  s_branch lw_79
lwe_80:
k_f_go:
  s_setprio 0
  s_lshl_b32 s3, s4, 8
  s_add_u32 s3, s3, 16777216
  buffer_load_dwordx4 v[112:115], v7, s[44:47], s8 offen offset:0 sc1
  buffer_load_dwordx4 v[120:123], v7, s[44:47], s9 offen offset:0 sc1
  buffer_load_dwordx4 v[116:119], v7, s[44:47], s8 offen offset:1024 sc1
  buffer_load_dwordx4 v[124:127], v7, s[44:47], s9 offen offset:1024 sc1
  buffer_load_dword v5, v4, s[44:47], s8 offen sc1
  buffer_load_dwordx4 v[128:131], v7, s[44:47], s8 offen offset:2048 sc1
  buffer_load_dwordx4 v[136:139], v7, s[44:47], s9 offen offset:2048 sc1
  buffer_load_dwordx4 v[132:135], v7, s[44:47], s8 offen offset:3072 sc1
  buffer_load_dwordx4 v[140:143], v7, s[44:47], s9 offen offset:3072 sc1
  s_add_u32 s8, s8, 4096
  s_add_u32 s9, s9, 4096
  buffer_load_dwordx4 v[144:147], v7, s[44:47], s8 offen offset:0 sc1
  buffer_load_dwordx4 v[152:155], v7, s[44:47], s9 offen offset:0 sc1
  buffer_load_dwordx4 v[148:151], v7, s[44:47], s8 offen offset:1024 sc1
  buffer_load_dwordx4 v[156:159], v7, s[44:47], s9 offen offset:1024 sc1
  buffer_load_dword v1, v6, s[44:47], s3 offen sc1
  buffer_load_dword v13, v6, s[44:47], s3 offen offset:128 sc1
  s_lshl_b32 s10, s74, 2
  s_add_u32 s10, s10, 36928
  v_mov_b32 v240, s10
  s_mov_b32 s14, 0
lw_81:
  ds_read_b32 v241, v240
  s_add_u32 s14, s14, 1
  s_waitcnt lgkmcnt(0)
  v_readfirstlane_b32 s15, v241
  s_cmp_gt_u32 s14, 0x200000
  s_cbranch_scc1 lwe_82
  s_cmp_ge_u32 s15, 3
  s_cbranch_scc1 lwe_82
  s_sleep 4
  s_branch lw_81
lwe_82:
  s_waitcnt vmcnt(15)
  ds_read_b64_tr_b16 v[80:81], v14 offset:0
  ds_read_b64_tr_b16 v[82:83], v14 offset:1024
  ds_read_b64_tr_b16 v[88:89], v15 offset:0
  ds_read_b64_tr_b16 v[90:91], v15 offset:1024
  ds_read_b64_tr_b16 v[84:85], v14 offset:2048
  ds_read_b64_tr_b16 v[86:87], v14 offset:3072
  ds_read_b64_tr_b16 v[92:93], v15 offset:2048
  ds_read_b64_tr_b16 v[94:95], v15 offset:3072
  s_waitcnt vmcnt(11) lgkmcnt(0)
  v_mfma_f32_32x32x16_bf16 v[16:31], v[80:83], v[112:115], v[16:31]
  ds_read_b64_tr_b16 v[96:97], v14 offset:4096
  ds_read_b64_tr_b16 v[98:99], v14 offset:5120
  s_add_u32 m0, s6, 12288
  s_nop 0
  buffer_load_dwordx4 v8, s[52:55], s7 offen lds
  v_mfma_f32_32x32x16_bf16 v[32:47], v[88:91], v[112:115], v[32:47]
  ds_read_b64_tr_b16 v[104:105], v15 offset:4096
  ds_read_b64_tr_b16 v[106:107], v15 offset:5120
  buffer_load_dwordx4 v9, s[52:55], s7 offen offset:1024 lds
  v_mfma_f32_32x32x16_bf16 v[48:63], v[80:83], v[120:123], v[48:63]
  ds_read_b64_tr_b16 v[100:101], v14 offset:6144
  ds_read_b64_tr_b16 v[102:103], v14 offset:7168
  buffer_load_dwordx4 v10, s[52:55], s7 offen offset:2048 lds
  v_mfma_f32_32x32x16_bf16 v[64:79], v[88:91], v[120:123], v[64:79]
  ds_read_b64_tr_b16 v[108:109], v15 offset:6144
  ds_read_b64_tr_b16 v[110:111], v15 offset:7168
  buffer_load_dwordx4 v11, s[52:55], s7 offen offset:3072 lds
  s_add_u32 s7, s7, 28672
  v_mfma_f32_32x32x16_bf16 v[16:31], v[84:87], v[116:119], v[16:31]
  buffer_load_dwordx4 v[112:115], v7, s[44:47], s8 offen offset:2048 sc1
  v_mfma_f32_32x32x16_bf16 v[32:47], v[92:95], v[116:119], v[32:47]
  buffer_load_dwordx4 v[120:123], v7, s[44:47], s9 offen offset:2048 sc1
  v_mfma_f32_32x32x16_bf16 v[48:63], v[84:87], v[124:127], v[48:63]
  v_mfma_f32_32x32x16_bf16 v[64:79], v[92:95], v[124:127], v[64:79]
  buffer_load_dwordx4 v[116:119], v7, s[44:47], s8 offen offset:3072 sc1
  buffer_load_dwordx4 v[124:127], v7, s[44:47], s9 offen offset:3072 sc1
  s_add_u32 s8, s8, 4096
  s_add_u32 s9, s9, 4096
  s_waitcnt vmcnt(14) lgkmcnt(0)
  v_mfma_f32_32x32x16_bf16 v[16:31], v[96:99], v[128:131], v[16:31]
  ds_read_b64_tr_b16 v[80:81], v14 offset:8192
  ds_read_b64_tr_b16 v[82:83], v14 offset:9216
  s_add_u32 m0, s6, 0
  s_nop 0
  buffer_load_dwordx4 v8, s[52:55], s7 offen lds
  v_mfma_f32_32x32x16_bf16 v[32:47], v[104:107], v[128:131], v[32:47]
  ds_read_b64_tr_b16 v[88:89], v15 offset:8192
  ds_read_b64_tr_b16 v[90:91], v15 offset:9216
  buffer_load_dwordx4 v9, s[52:55], s7 offen offset:1024 lds
  v_mfma_f32_32x32x16_bf16 v[48:63], v[96:99], v[136:139], v[48:63]
  ds_read_b64_tr_b16 v[84:85], v14 offset:10240
  ds_read_b64_tr_b16 v[86:87], v14 offset:11264
  buffer_load_dwordx4 v10, s[52:55], s7 offen offset:2048 lds
  v_mfma_f32_32x32x16_bf16 v[64:79], v[104:107], v[136:139], v[64:79]
  ds_read_b64_tr_b16 v[92:93], v15 offset:10240
  ds_read_b64_tr_b16 v[94:95], v15 offset:11264
  buffer_load_dwordx4 v11, s[52:55], s7 offen offset:3072 lds
  s_add_u32 s7, s7, 28672
  v_mfma_f32_32x32x16_bf16 v[16:31], v[100:103], v[132:135], v[16:31]
  buffer_load_dwordx4 v[128:131], v7, s[44:47], s8 offen offset:0 sc1
  v_mfma_f32_32x32x16_bf16 v[32:47], v[108:111], v[132:135], v[32:47]
  buffer_load_dwordx4 v[136:139], v7, s[44:47], s9 offen offset:0 sc1
  v_mfma_f32_32x32x16_bf16 v[48:63], v[100:103], v[140:143], v[48:63]
  v_mfma_f32_32x32x16_bf16 v[64:79], v[108:111], v[140:143], v[64:79]
  buffer_load_dwordx4 v[132:135], v7, s[44:47], s8 offen offset:1024 sc1
  buffer_load_dwordx4 v[140:143], v7, s[44:47], s9 offen offset:1024 sc1
  s_waitcnt vmcnt(12) lgkmcnt(0)
  v_mfma_f32_32x32x16_bf16 v[16:31], v[80:83], v[144:147], v[16:31]
  ds_read_b64_tr_b16 v[96:97], v14 offset:12288
  ds_read_b64_tr_b16 v[98:99], v14 offset:13312
  s_add_u32 m0, s6, 4096
  s_nop 0
  buffer_load_dwordx4 v8, s[52:55], s7 offen lds
  v_mfma_f32_32x32x16_bf16 v[32:47], v[88:91], v[144:147], v[32:47]
  ds_read_b64_tr_b16 v[104:105], v15 offset:12288
  ds_read_b64_tr_b16 v[106:107], v15 offset:13312
  buffer_load_dwordx4 v9, s[52:55], s7 offen offset:1024 lds
  v_mfma_f32_32x32x16_bf16 v[48:63], v[80:83], v[152:155], v[48:63]
  ds_read_b64_tr_b16 v[100:101], v14 offset:14336
  ds_read_b64_tr_b16 v[102:103], v14 offset:15360
  buffer_load_dwordx4 v10, s[52:55], s7 offen offset:2048 lds
  v_mfma_f32_32x32x16_bf16 v[64:79], v[88:91], v[152:155], v[64:79]
  ds_read_b64_tr_b16 v[108:109], v15 offset:14336
  ds_read_b64_tr_b16 v[110:111], v15 offset:15360
  buffer_load_dwordx4 v11, s[52:55], s7 offen offset:3072 lds
  s_add_u32 s7, s7, 28672
  v_mfma_f32_32x32x16_bf16 v[16:31], v[84:87], v[148:151], v[16:31]
  buffer_load_dwordx4 v[144:147], v7, s[44:47], s8 offen offset:2048 sc1
  v_mfma_f32_32x32x16_bf16 v[32:47], v[92:95], v[148:151], v[32:47]
  buffer_load_dwordx4 v[152:155], v7, s[44:47], s9 offen offset:2048 sc1
  v_mfma_f32_32x32x16_bf16 v[48:63], v[84:87], v[156:159], v[48:63]
  v_mfma_f32_32x32x16_bf16 v[64:79], v[92:95], v[156:159], v[64:79]
  buffer_load_dwordx4 v[148:151], v7, s[44:47], s8 offen offset:3072 sc1
  buffer_load_dwordx4 v[156:159], v7, s[44:47], s9 offen offset:3072 sc1
  s_add_u32 s8, s8, 4096
  s_add_u32 s9, s9, 4096
  s_waitcnt vmcnt(12) lgkmcnt(0)
  v_mfma_f32_32x32x16_bf16 v[16:31], v[96:99], v[112:115], v[16:31]
  ds_read_b64_tr_b16 v[80:81], v14 offset:0
  ds_read_b64_tr_b16 v[82:83], v14 offset:1024
  s_add_u32 m0, s6, 8192
  s_nop 0
  buffer_load_dwordx4 v8, s[52:55], s7 offen lds
  v_mfma_f32_32x32x16_bf16 v[32:47], v[104:107], v[112:115], v[32:47]
  ds_read_b64_tr_b16 v[88:89], v15 offset:0
  ds_read_b64_tr_b16 v[90:91], v15 offset:1024
  buffer_load_dwordx4 v9, s[52:55], s7 offen offset:1024 lds
  v_mfma_f32_32x32x16_bf16 v[48:63], v[96:99], v[120:123], v[48:63]
  ds_read_b64_tr_b16 v[84:85], v14 offset:2048
  ds_read_b64_tr_b16 v[86:87], v14 offset:3072
  buffer_load_dwordx4 v10, s[52:55], s7 offen offset:2048 lds
  v_mfma_f32_32x32x16_bf16 v[64:79], v[104:107], v[120:123], v[64:79]
  ds_read_b64_tr_b16 v[92:93], v15 offset:2048
  ds_read_b64_tr_b16 v[94:95], v15 offset:3072
  buffer_load_dwordx4 v11, s[52:55], s7 offen offset:3072 lds
  s_add_u32 s7, s7, 28672
  v_mfma_f32_32x32x16_bf16 v[16:31], v[100:103], v[116:119], v[16:31]
  buffer_load_dwordx4 v[112:115], v7, s[44:47], s8 offen offset:0 sc1
  v_mfma_f32_32x32x16_bf16 v[32:47], v[108:111], v[116:119], v[32:47]
  buffer_load_dwordx4 v[120:123], v7, s[44:47], s9 offen offset:0 sc1
  v_mfma_f32_32x32x16_bf16 v[48:63], v[100:103], v[124:127], v[48:63]
  v_mfma_f32_32x32x16_bf16 v[64:79], v[108:111], v[124:127], v[64:79]
  buffer_load_dwordx4 v[116:119], v7, s[44:47], s8 offen offset:1024 sc1
  buffer_load_dwordx4 v[124:127], v7, s[44:47], s9 offen offset:1024 sc1
  s_waitcnt vmcnt(12) lgkmcnt(0)
  v_mfma_f32_32x32x16_bf16 v[16:31], v[80:83], v[128:131], v[16:31]
  ds_read_b64_tr_b16 v[96:97], v14 offset:4096
  ds_read_b64_tr_b16 v[98:99], v14 offset:5120
  s_add_u32 m0, s6, 12288
  s_nop 0
  buffer_load_dwordx4 v8, s[52:55], s7 offen lds
  v_mfma_f32_32x32x16_bf16 v[32:47], v[88:91], v[128:131], v[32:47]
  ds_read_b64_tr_b16 v[104:105], v15 offset:4096
  ds_read_b64_tr_b16 v[106:107], v15 offset:5120
  buffer_load_dwordx4 v9, s[52:55], s7 offen offset:1024 lds
  v_mfma_f32_32x32x16_bf16 v[48:63], v[80:83], v[136:139], v[48:63]
  ds_read_b64_tr_b16 v[100:101], v14 offset:6144
  ds_read_b64_tr_b16 v[102:103], v14 offset:7168
  buffer_load_dwordx4 v10, s[52:55], s7 offen offset:2048 lds
  v_mfma_f32_32x32x16_bf16 v[64:79], v[88:91], v[136:139], v[64:79]
  ds_read_b64_tr_b16 v[108:109], v15 offset:6144
  ds_read_b64_tr_b16 v[110:111], v15 offset:7168
  buffer_load_dwordx4 v11, s[52:55], s7 offen offset:3072 lds
  s_add_u32 s7, s7, 28672
  v_mfma_f32_32x32x16_bf16 v[16:31], v[84:87], v[132:135], v[16:31]
  buffer_load_dwordx4 v[128:131], v7, s[44:47], s8 offen offset:2048 sc1
  v_mfma_f32_32x32x16_bf16 v[32:47], v[92:95], v[132:135], v[32:47]
  buffer_load_dwordx4 v[136:139], v7, s[44:47], s9 offen offset:2048 sc1
  v_mfma_f32_32x32x16_bf16 v[48:63], v[84:87], v[140:143], v[48:63]
  v_mfma_f32_32x32x16_bf16 v[64:79], v[92:95], v[140:143], v[64:79]
  buffer_load_dwordx4 v[132:135], v7, s[44:47], s8 offen offset:3072 sc1
  buffer_load_dwordx4 v[140:143], v7, s[44:47], s9 offen offset:3072 sc1
  s_add_u32 s8, s8, 4096
  s_add_u32 s9, s9, 4096
  s_waitcnt vmcnt(12) lgkmcnt(0)
  v_mfma_f32_32x32x16_bf16 v[16:31], v[96:99], v[144:147], v[16:31]
  ds_read_b64_tr_b16 v[80:81], v14 offset:8192
  ds_read_b64_tr_b16 v[82:83], v14 offset:9216
  s_add_u32 m0, s6, 0
  s_nop 0
  buffer_load_dwordx4 v8, s[52:55], s7 offen lds
  v_mfma_f32_32x32x16_bf16 v[32:47], v[104:107], v[144:147], v[32:47]
  ds_read_b64_tr_b16 v[88:89], v15 offset:8192
  ds_read_b64_tr_b16 v[90:91], v15 offset:9216
  buffer_load_dwordx4 v9, s[52:55], s7 offen offset:1024 lds
  v_mfma_f32_32x32x16_bf16 v[48:63], v[96:99], v[152:155], v[48:63]
  ds_read_b64_tr_b16 v[84:85], v14 offset:10240
  ds_read_b64_tr_b16 v[86:87], v14 offset:11264
  buffer_load_dwordx4 v10, s[52:55], s7 offen offset:2048 lds
  v_mfma_f32_32x32x16_bf16 v[64:79], v[104:107], v[152:155], v[64:79]
  ds_read_b64_tr_b16 v[92:93], v15 offset:10240
  ds_read_b64_tr_b16 v[94:95], v15 offset:11264
  buffer_load_dwordx4 v11, s[52:55], s7 offen offset:3072 lds
  s_add_u32 s7, s7, 28672
  v_mfma_f32_32x32x16_bf16 v[16:31], v[100:103], v[148:151], v[16:31]
  buffer_load_dwordx4 v[144:147], v7, s[44:47], s8 offen offset:0 sc1
  v_mfma_f32_32x32x16_bf16 v[32:47], v[108:111], v[148:151], v[32:47]
  buffer_load_dwordx4 v[152:155], v7, s[44:47], s9 offen offset:0 sc1
  v_mfma_f32_32x32x16_bf16 v[48:63], v[100:103], v[156:159], v[48:63]
  v_mfma_f32_32x32x16_bf16 v[64:79], v[108:111], v[156:159], v[64:79]
  buffer_load_dwordx4 v[148:151], v7, s[44:47], s8 offen offset:1024 sc1
  buffer_load_dwordx4 v[156:159], v7, s[44:47], s9 offen offset:1024 sc1
  s_waitcnt vmcnt(12) lgkmcnt(0)
  v_mfma_f32_32x32x16_bf16 v[16:31], v[80:83], v[112:115], v[16:31]
  ds_read_b64_tr_b16 v[96:97], v14 offset:12288
  ds_read_b64_tr_b16 v[98:99], v14 offset:13312
  s_add_u32 m0, s6, 4096
  s_nop 0
  buffer_load_dwordx4 v8, s[52:55], s7 offen lds
  v_mfma_f32_32x32x16_bf16 v[32:47], v[88:91], v[112:115], v[32:47]
  ds_read_b64_tr_b16 v[104:105], v15 offset:12288
  ds_read_b64_tr_b16 v[106:107], v15 offset:13312
  buffer_load_dwordx4 v9, s[52:55], s7 offen offset:1024 lds
  v_mfma_f32_32x32x16_bf16 v[48:63], v[80:83], v[120:123], v[48:63]
  ds_read_b64_tr_b16 v[100:101], v14 offset:14336
  ds_read_b64_tr_b16 v[102:103], v14 offset:15360
  buffer_load_dwordx4 v10, s[52:55], s7 offen offset:2048 lds
  v_mfma_f32_32x32x16_bf16 v[64:79], v[88:91], v[120:123], v[64:79]
  ds_read_b64_tr_b16 v[108:109], v15 offset:14336
  ds_read_b64_tr_b16 v[110:111], v15 offset:15360
  buffer_load_dwordx4 v11, s[52:55], s7 offen offset:3072 lds
  s_add_u32 s7, s7, 28672
  v_mfma_f32_32x32x16_bf16 v[16:31], v[84:87], v[116:119], v[16:31]
  buffer_load_dwordx4 v[112:115], v7, s[44:47], s8 offen offset:2048 sc1
  v_mfma_f32_32x32x16_bf16 v[32:47], v[92:95], v[116:119], v[32:47]
  buffer_load_dwordx4 v[120:123], v7, s[44:47], s9 offen offset:2048 sc1
  v_mfma_f32_32x32x16_bf16 v[48:63], v[84:87], v[124:127], v[48:63]
  v_mfma_f32_32x32x16_bf16 v[64:79], v[92:95], v[124:127], v[64:79]
  buffer_load_dwordx4 v[116:119], v7, s[44:47], s8 offen offset:3072 sc1
  buffer_load_dwordx4 v[124:127], v7, s[44:47], s9 offen offset:3072 sc1
  s_add_u32 s8, s8, 4096
  s_add_u32 s9, s9, 4096
  s_waitcnt vmcnt(12) lgkmcnt(0)
  v_mfma_f32_32x32x16_bf16 v[16:31], v[96:99], v[128:131], v[16:31]
  ds_read_b64_tr_b16 v[80:81], v14 offset:0
  ds_read_b64_tr_b16 v[82:83], v14 offset:1024
  s_add_u32 m0, s6, 8192
  s_nop 0
  buffer_load_dwordx4 v8, s[52:55], s7 offen lds
  v_mfma_f32_32x32x16_bf16 v[32:47], v[104:107], v[128:131], v[32:47]
  ds_read_b64_tr_b16 v[88:89], v15 offset:0
  ds_read_b64_tr_b16 v[90:91], v15 offset:1024
  buffer_load_dwordx4 v9, s[52:55], s7 offen offset:1024 lds
  v_mfma_f32_32x32x16_bf16 v[48:63], v[96:99], v[136:139], v[48:63]
  ds_read_b64_tr_b16 v[84:85], v14 offset:2048
  ds_read_b64_tr_b16 v[86:87], v14 offset:3072
  buffer_load_dwordx4 v10, s[52:55], s7 offen offset:2048 lds
  v_mfma_f32_32x32x16_bf16 v[64:79], v[104:107], v[136:139], v[64:79]
  ds_read_b64_tr_b16 v[92:93], v15 offset:2048
  ds_read_b64_tr_b16 v[94:95], v15 offset:3072
  buffer_load_dwordx4 v11, s[52:55], s7 offen offset:3072 lds
  s_add_u32 s7, s7, 28672
  v_mfma_f32_32x32x16_bf16 v[16:31], v[100:103], v[132:135], v[16:31]
  buffer_load_dwordx4 v[128:131], v7, s[44:47], s8 offen offset:0 sc1
  v_mfma_f32_32x32x16_bf16 v[32:47], v[108:111], v[132:135], v[32:47]
  buffer_load_dwordx4 v[136:139], v7, s[44:47], s9 offen offset:0 sc1
  v_mfma_f32_32x32x16_bf16 v[48:63], v[100:103], v[140:143], v[48:63]
  v_mfma_f32_32x32x16_bf16 v[64:79], v[108:111], v[140:143], v[64:79]
  buffer_load_dwordx4 v[132:135], v7, s[44:47], s8 offen offset:1024 sc1
  buffer_load_dwordx4 v[140:143], v7, s[44:47], s9 offen offset:1024 sc1
  s_waitcnt vmcnt(12) lgkmcnt(0)
  v_mfma_f32_32x32x16_bf16 v[16:31], v[80:83], v[144:147], v[16:31]
  ds_read_b64_tr_b16 v[96:97], v14 offset:4096
  ds_read_b64_tr_b16 v[98:99], v14 offset:5120
  s_add_u32 m0, s6, 12288
  s_nop 0
  buffer_load_dwordx4 v8, s[52:55], s7 offen lds
  v_mfma_f32_32x32x16_bf16 v[32:47], v[88:91], v[144:147], v[32:47]
  ds_read_b64_tr_b16 v[104:105], v15 offset:4096
  ds_read_b64_tr_b16 v[106:107], v15 offset:5120
  buffer_load_dwordx4 v9, s[52:55], s7 offen offset:1024 lds
  v_mfma_f32_32x32x16_bf16 v[48:63], v[80:83], v[152:155], v[48:63]
  ds_read_b64_tr_b16 v[100:101], v14 offset:6144
  ds_read_b64_tr_b16 v[102:103], v14 offset:7168
  buffer_load_dwordx4 v10, s[52:55], s7 offen offset:2048 lds
  v_mfma_f32_32x32x16_bf16 v[64:79], v[88:91], v[152:155], v[64:79]
  ds_read_b64_tr_b16 v[108:109], v15 offset:6144
  ds_read_b64_tr_b16 v[110:111], v15 offset:7168
  buffer_load_dwordx4 v11, s[52:55], s7 offen offset:3072 lds
  s_add_u32 s7, s7, 28672
  v_mfma_f32_32x32x16_bf16 v[16:31], v[84:87], v[148:151], v[16:31]
  buffer_load_dwordx4 v[144:147], v7, s[44:47], s8 offen offset:2048 sc1
  v_mfma_f32_32x32x16_bf16 v[32:47], v[92:95], v[148:151], v[32:47]
  buffer_load_dwordx4 v[152:155], v7, s[44:47], s9 offen offset:2048 sc1
  v_mfma_f32_32x32x16_bf16 v[48:63], v[84:87], v[156:159], v[48:63]
  v_mfma_f32_32x32x16_bf16 v[64:79], v[92:95], v[156:159], v[64:79]
  buffer_load_dwordx4 v[148:151], v7, s[44:47], s8 offen offset:3072 sc1
  buffer_load_dwordx4 v[156:159], v7, s[44:47], s9 offen offset:3072 sc1
  s_add_u32 s8, s8, 4096
  s_add_u32 s9, s9, 4096
  s_waitcnt vmcnt(12) lgkmcnt(0)
  v_mfma_f32_32x32x16_bf16 v[16:31], v[96:99], v[112:115], v[16:31]
  ds_read_b64_tr_b16 v[80:81], v14 offset:8192
  ds_read_b64_tr_b16 v[82:83], v14 offset:9216
  s_add_u32 m0, s6, 0
  s_nop 0
  buffer_load_dwordx4 v8, s[52:55], s7 offen lds
  v_mfma_f32_32x32x16_bf16 v[32:47], v[104:107], v[112:115], v[32:47]
  ds_read_b64_tr_b16 v[88:89], v15 offset:8192
  ds_read_b64_tr_b16 v[90:91], v15 offset:9216
  buffer_load_dwordx4 v9, s[52:55], s7 offen offset:1024 lds
  v_mfma_f32_32x32x16_bf16 v[48:63], v[96:99], v[120:123], v[48:63]
  ds_read_b64_tr_b16 v[84:85], v14 offset:10240
  ds_read_b64_tr_b16 v[86:87], v14 offset:11264
  buffer_load_dwordx4 v10, s[52:55], s7 offen offset:2048 lds
  v_mfma_f32_32x32x16_bf16 v[64:79], v[104:107], v[120:123], v[64:79]
  ds_read_b64_tr_b16 v[92:93], v15 offset:10240
  ds_read_b64_tr_b16 v[94:95], v15 offset:11264
  buffer_load_dwordx4 v11, s[52:55], s7 offen offset:3072 lds
  s_add_u32 s7, s7, 28672
  v_mfma_f32_32x32x16_bf16 v[16:31], v[100:103], v[116:119], v[16:31]
  buffer_load_dwordx4 v[112:115], v7, s[44:47], s8 offen offset:0 sc1
  v_mfma_f32_32x32x16_bf16 v[32:47], v[108:111], v[116:119], v[32:47]
  buffer_load_dwordx4 v[120:123], v7, s[44:47], s9 offen offset:0 sc1
  v_mfma_f32_32x32x16_bf16 v[48:63], v[100:103], v[124:127], v[48:63]
  v_mfma_f32_32x32x16_bf16 v[64:79], v[108:111], v[124:127], v[64:79]
  buffer_load_dwordx4 v[116:119], v7, s[44:47], s8 offen offset:1024 sc1
  buffer_load_dwordx4 v[124:127], v7, s[44:47], s9 offen offset:1024 sc1
  s_waitcnt vmcnt(12) lgkmcnt(0)
  v_mfma_f32_32x32x16_bf16 v[16:31], v[80:83], v[128:131], v[16:31]
  ds_read_b64_tr_b16 v[96:97], v14 offset:12288
  ds_read_b64_tr_b16 v[98:99], v14 offset:13312
  s_add_u32 m0, s6, 4096
  s_nop 0
  buffer_load_dwordx4 v8, s[52:55], s7 offen lds
  v_mfma_f32_32x32x16_bf16 v[32:47], v[88:91], v[128:131], v[32:47]
  ds_read_b64_tr_b16 v[104:105], v15 offset:12288
  ds_read_b64_tr_b16 v[106:107], v15 offset:13312
  buffer_load_dwordx4 v9, s[52:55], s7 offen offset:1024 lds
  v_mfma_f32_32x32x16_bf16 v[48:63], v[80:83], v[136:139], v[48:63]
  ds_read_b64_tr_b16 v[100:101], v14 offset:14336
  ds_read_b64_tr_b16 v[102:103], v14 offset:15360
  buffer_load_dwordx4 v10, s[52:55], s7 offen offset:2048 lds
  v_mfma_f32_32x32x16_bf16 v[64:79], v[88:91], v[136:139], v[64:79]
  ds_read_b64_tr_b16 v[108:109], v15 offset:14336
  ds_read_b64_tr_b16 v[110:111], v15 offset:15360
  buffer_load_dwordx4 v11, s[52:55], s7 offen offset:3072 lds
  s_add_u32 s7, s7, 28672
  v_mfma_f32_32x32x16_bf16 v[16:31], v[84:87], v[132:135], v[16:31]
  buffer_load_dwordx4 v[128:131], v7, s[44:47], s8 offen offset:2048 sc1
  v_mfma_f32_32x32x16_bf16 v[32:47], v[92:95], v[132:135], v[32:47]
  buffer_load_dwordx4 v[136:139], v7, s[44:47], s9 offen offset:2048 sc1
  v_mfma_f32_32x32x16_bf16 v[48:63], v[84:87], v[140:143], v[48:63]
  v_mfma_f32_32x32x16_bf16 v[64:79], v[92:95], v[140:143], v[64:79]
  buffer_load_dwordx4 v[132:135], v7, s[44:47], s8 offen offset:3072 sc1
  buffer_load_dwordx4 v[140:143], v7, s[44:47], s9 offen offset:3072 sc1
  s_add_u32 s8, s8, 4096
  s_add_u32 s9, s9, 4096
  s_waitcnt vmcnt(12) lgkmcnt(0)
  v_mfma_f32_32x32x16_bf16 v[16:31], v[96:99], v[144:147], v[16:31]
  ds_read_b64_tr_b16 v[80:81], v14 offset:0
  ds_read_b64_tr_b16 v[82:83], v14 offset:1024
  v_mfma_f32_32x32x16_bf16 v[32:47], v[104:107], v[144:147], v[32:47]
  ds_read_b64_tr_b16 v[88:89], v15 offset:0
  ds_read_b64_tr_b16 v[90:91], v15 offset:1024
  v_mfma_f32_32x32x16_bf16 v[48:63], v[96:99], v[152:155], v[48:63]
  ds_read_b64_tr_b16 v[84:85], v14 offset:2048
  ds_read_b64_tr_b16 v[86:87], v14 offset:3072
  v_mfma_f32_32x32x16_bf16 v[64:79], v[104:107], v[152:155], v[64:79]
  ds_read_b64_tr_b16 v[92:93], v15 offset:2048
  ds_read_b64_tr_b16 v[94:95], v15 offset:3072
  v_mfma_f32_32x32x16_bf16 v[16:31], v[100:103], v[148:151], v[16:31]
  v_mfma_f32_32x32x16_bf16 v[32:47], v[108:111], v[148:151], v[32:47]
  v_mfma_f32_32x32x16_bf16 v[48:63], v[100:103], v[156:159], v[48:63]
  v_mfma_f32_32x32x16_bf16 v[64:79], v[108:111], v[156:159], v[64:79]
  s_waitcnt vmcnt(4) lgkmcnt(0)
  v_mfma_f32_32x32x16_bf16 v[16:31], v[80:83], v[112:115], v[16:31]
  ds_read_b64_tr_b16 v[96:97], v14 offset:4096
  ds_read_b64_tr_b16 v[98:99], v14 offset:5120
  v_mfma_f32_32x32x16_bf16 v[32:47], v[88:91], v[112:115], v[32:47]
  ds_read_b64_tr_b16 v[104:105], v15 offset:4096
  ds_read_b64_tr_b16 v[106:107], v15 offset:5120
  v_mfma_f32_32x32x16_bf16 v[48:63], v[80:83], v[120:123], v[48:63]
  ds_read_b64_tr_b16 v[100:101], v14 offset:6144
  ds_read_b64_tr_b16 v[102:103], v14 offset:7168
  v_mfma_f32_32x32x16_bf16 v[64:79], v[88:91], v[120:123], v[64:79]
  ds_read_b64_tr_b16 v[108:109], v15 offset:6144
  ds_read_b64_tr_b16 v[110:111], v15 offset:7168
  v_mfma_f32_32x32x16_bf16 v[16:31], v[84:87], v[116:119], v[16:31]
  v_mfma_f32_32x32x16_bf16 v[32:47], v[92:95], v[116:119], v[32:47]
  v_mfma_f32_32x32x16_bf16 v[48:63], v[84:87], v[124:127], v[48:63]
  v_mfma_f32_32x32x16_bf16 v[64:79], v[92:95], v[124:127], v[64:79]
  s_waitcnt vmcnt(0) lgkmcnt(0)
  v_mfma_f32_32x32x16_bf16 v[16:31], v[96:99], v[128:131], v[16:31]
  v_mfma_f32_32x32x16_bf16 v[32:47], v[104:107], v[128:131], v[32:47]
  v_mfma_f32_32x32x16_bf16 v[48:63], v[96:99], v[136:139], v[48:63]
  v_mfma_f32_32x32x16_bf16 v[64:79], v[104:107], v[136:139], v[64:79]
  v_mfma_f32_32x32x16_bf16 v[16:31], v[100:103], v[132:135], v[16:31]
  v_mfma_f32_32x32x16_bf16 v[32:47], v[108:111], v[132:135], v[32:47]
  v_mfma_f32_32x32x16_bf16 v[48:63], v[100:103], v[140:143], v[48:63]
  v_mfma_f32_32x32x16_bf16 v[64:79], v[108:111], v[140:143], v[64:79]
  s_waitcnt vmcnt(0) lgkmcnt(0)
  s_setprio 2
  v_sub_f32 v4, 1.0, v1
  v_sub_f32 v6, 1.0, v13
  s_nop 7
  v_mul_f32 v16, v4, v16
  v_mul_f32 v17, v4, v17
  v_mul_f32 v18, v4, v18
  v_mul_f32 v19, v4, v19
  v_mul_f32 v20, v4, v20
  v_mul_f32 v21, v4, v21
  v_mul_f32 v22, v4, v22
  v_mul_f32 v23, v4, v23
  v_mul_f32 v24, v4, v24
  v_mul_f32 v25, v4, v25
  v_mul_f32 v26, v4, v26
  v_mul_f32 v27, v4, v27
  v_mul_f32 v28, v4, v28
  v_mul_f32 v29, v4, v29
  v_mul_f32 v30, v4, v30
  v_mul_f32 v31, v4, v31
  v_mul_f32 v32, v4, v32
  v_mul_f32 v33, v4, v33
  v_mul_f32 v34, v4, v34
  v_mul_f32 v35, v4, v35
  v_mul_f32 v36, v4, v36
  v_mul_f32 v37, v4, v37
  v_mul_f32 v38, v4, v38
  v_mul_f32 v39, v4, v39
  v_mul_f32 v40, v4, v40
  v_mul_f32 v41, v4, v41
  v_mul_f32 v42, v4, v42
  v_mul_f32 v43, v4, v43
  v_mul_f32 v44, v4, v44
  v_mul_f32 v45, v4, v45
  v_mul_f32 v46, v4, v46
  v_mul_f32 v47, v4, v47
  v_mul_f32 v48, v6, v48
  v_mul_f32 v49, v6, v49
  v_mul_f32 v50, v6, v50
  v_mul_f32 v51, v6, v51
  v_mul_f32 v52, v6, v52
  v_mul_f32 v53, v6, v53
  v_mul_f32 v54, v6, v54
  v_mul_f32 v55, v6, v55
  v_mul_f32 v56, v6, v56
  v_mul_f32 v57, v6, v57
  v_mul_f32 v58, v6, v58
  v_mul_f32 v59, v6, v59
  v_mul_f32 v60, v6, v60
  v_mul_f32 v61, v6, v61
  v_mul_f32 v62, v6, v62
  v_mul_f32 v63, v6, v63
  v_mul_f32 v64, v6, v64
  v_mul_f32 v65, v6, v65
  v_mul_f32 v66, v6, v66
  v_mul_f32 v67, v6, v67
  v_mul_f32 v68, v6, v68
  v_mul_f32 v69, v6, v69
  v_mul_f32 v70, v6, v70
  v_mul_f32 v71, v6, v71
  v_mul_f32 v72, v6, v72
  v_mul_f32 v73, v6, v73
  v_mul_f32 v74, v6, v74
  v_mul_f32 v75, v6, v75
  v_mul_f32 v76, v6, v76
  v_mul_f32 v77, v6, v77
  v_mul_f32 v78, v6, v78
  v_mul_f32 v79, v6, v79
  v_lshrrev_b32 v1, 2, v0
  v_lshlrev_b32 v1, 7, v1
  v_and_b32 v13, 3, v0
  v_lshl_add_u32 v1, v13, 3, v1
  s_lshl_b32 s3, s4, 8
  s_lshl_b32 s79, s74, 5
  s_add_u32 s3, s3, s79
  s_add_u32 s79, s3, 16859136
  s_lshl_b32 s3, s4, 5
  s_lshl_b32 s8, s74, 2
  s_add_u32 s3, s3, s8
  s_lshl_b32 s3, s3, 11
  s_add_u32 s8, s3, 14680064
  s_add_u32 s7, s8, 32768
  s_waitcnt vmcnt(0)
  v_mov_b32 v8, 36876
  s_mov_b32 s14, 0
lw_83:
  ds_read_b32 v9, v8
  s_add_u32 s14, s14, 1
  s_waitcnt lgkmcnt(0)
  v_readfirstlane_b32 s15, v9
  s_cmp_gt_u32 s14, 0x200000
  s_cbranch_scc1 lwe_84
  s_cmp_ge_u32 s15, 4
  s_cbranch_scc1 lwe_84
  s_sleep 1
  s_branch lw_83
lwe_84:
  s_setprio 3
  s_mov_b32 exec_lo, 0xff
  s_mov_b32 exec_hi, 0x0
  s_mov_b32 s14, 0
pl_85:
  buffer_load_dwordx2 v[8:9], v1, s[44:47], s79 offen sc1
  s_add_u32 s14, s14, 1
  s_waitcnt vmcnt(0)
  v_cmp_eq_u64 vcc, s[12:13], v[8:9]
  s_cmp_gt_u32 s14, 0x40000
  s_cbranch_scc1 ple_86
  s_cmp_eq_u64 vcc, exec
  s_cbranch_scc1 ple_86
  s_sleep 3
  s_branch pl_85
ple_86:
  s_mov_b64 exec, -1
  buffer_load_dwordx4 v[80:83], v7, s[44:47], s8 offen offset:0 sc1
  buffer_load_dwordx4 v[84:87], v7, s[44:47], s7 offen offset:0 sc1
  buffer_load_dwordx4 v[88:91], v7, s[44:47], s8 offen offset:1024 sc1
  buffer_load_dwordx4 v[92:95], v7, s[44:47], s7 offen offset:1024 sc1
  buffer_load_dwordx4 v[96:99], v7, s[44:47], s8 offen offset:2048 sc1
  buffer_load_dwordx4 v[100:103], v7, s[44:47], s7 offen offset:2048 sc1
  buffer_load_dwordx4 v[104:107], v7, s[44:47], s8 offen offset:3072 sc1
  buffer_load_dwordx4 v[108:111], v7, s[44:47], s7 offen offset:3072 sc1
  s_add_u32 s8, s8, 4096
  s_add_u32 s7, s7, 4096
  buffer_load_dwordx4 v[112:115], v7, s[44:47], s8 offen offset:0 sc1
  buffer_load_dwordx4 v[116:119], v7, s[44:47], s7 offen offset:0 sc1
  buffer_load_dwordx4 v[120:123], v7, s[44:47], s8 offen offset:1024 sc1
  buffer_load_dwordx4 v[124:127], v7, s[44:47], s7 offen offset:1024 sc1
  buffer_load_dwordx4 v[128:131], v7, s[44:47], s8 offen offset:2048 sc1
  buffer_load_dwordx4 v[132:135], v7, s[44:47], s7 offen offset:2048 sc1
  buffer_load_dwordx4 v[136:139], v7, s[44:47], s8 offen offset:3072 sc1
  buffer_load_dwordx4 v[140:143], v7, s[44:47], s7 offen offset:3072 sc1
  s_waitcnt vmcnt(14)
  v_mfma_f32_32x32x16_bf16 v[16:31], v[176:179], v[80:83], v[16:31]
  v_mfma_f32_32x32x16_bf16 v[32:47], v[180:183], v[80:83], v[32:47]
  v_mfma_f32_32x32x16_bf16 v[48:63], v[176:179], v[84:87], v[48:63]
  v_mfma_f32_32x32x16_bf16 v[64:79], v[180:183], v[84:87], v[64:79]
  s_waitcnt vmcnt(12)
  v_mfma_f32_32x32x16_bf16 v[16:31], v[184:187], v[88:91], v[16:31]
  v_mfma_f32_32x32x16_bf16 v[32:47], v[188:191], v[88:91], v[32:47]
  v_mfma_f32_32x32x16_bf16 v[48:63], v[184:187], v[92:95], v[48:63]
  v_mfma_f32_32x32x16_bf16 v[64:79], v[188:191], v[92:95], v[64:79]
  s_waitcnt vmcnt(10)
  v_mfma_f32_32x32x16_bf16 v[16:31], v[192:195], v[96:99], v[16:31]
  v_mfma_f32_32x32x16_bf16 v[32:47], v[196:199], v[96:99], v[32:47]
  v_mfma_f32_32x32x16_bf16 v[48:63], v[192:195], v[100:103], v[48:63]
  v_mfma_f32_32x32x16_bf16 v[64:79], v[196:199], v[100:103], v[64:79]
  s_waitcnt vmcnt(8)
  v_mfma_f32_32x32x16_bf16 v[16:31], v[200:203], v[104:107], v[16:31]
  v_mfma_f32_32x32x16_bf16 v[32:47], v[204:207], v[104:107], v[32:47]
  v_mfma_f32_32x32x16_bf16 v[48:63], v[200:203], v[108:111], v[48:63]
  v_mfma_f32_32x32x16_bf16 v[64:79], v[204:207], v[108:111], v[64:79]
  s_waitcnt vmcnt(6)
  v_mfma_f32_32x32x16_bf16 v[16:31], v[208:211], v[112:115], v[16:31]
  v_mfma_f32_32x32x16_bf16 v[32:47], v[212:215], v[112:115], v[32:47]
  v_mfma_f32_32x32x16_bf16 v[48:63], v[208:211], v[116:119], v[48:63]
  v_mfma_f32_32x32x16_bf16 v[64:79], v[212:215], v[116:119], v[64:79]
  s_waitcnt vmcnt(4)
  v_mfma_f32_32x32x16_bf16 v[16:31], v[216:219], v[120:123], v[16:31]
  v_mfma_f32_32x32x16_bf16 v[32:47], v[220:223], v[120:123], v[32:47]
  v_mfma_f32_32x32x16_bf16 v[48:63], v[216:219], v[124:127], v[48:63]
  v_mfma_f32_32x32x16_bf16 v[64:79], v[220:223], v[124:127], v[64:79]
  s_waitcnt vmcnt(2)
  v_mfma_f32_32x32x16_bf16 v[16:31], v[224:227], v[128:131], v[16:31]
  v_mfma_f32_32x32x16_bf16 v[32:47], v[228:231], v[128:131], v[32:47]
  v_mfma_f32_32x32x16_bf16 v[48:63], v[224:227], v[132:135], v[48:63]
  v_mfma_f32_32x32x16_bf16 v[64:79], v[228:231], v[132:135], v[64:79]
  s_waitcnt vmcnt(0)
  v_mfma_f32_32x32x16_bf16 v[16:31], v[232:235], v[136:139], v[16:31]
  v_mfma_f32_32x32x16_bf16 v[32:47], v[236:239], v[136:139], v[32:47]
  v_mfma_f32_32x32x16_bf16 v[48:63], v[232:235], v[140:143], v[48:63]
  v_mfma_f32_32x32x16_bf16 v[64:79], v[236:239], v[140:143], v[64:79]
  v_add_u32 v4, s11, v7
  s_lshl_b32 s3, s74, 12
  s_add_u32 s3, s3, 40960
  v_add_u32 v5, s3, v7
  s_nop 7
  s_cmp_lg_u32 s74, 0
  s_cbranch_scc1 k_red0_skip
  ds_write_b128 v4, v[32:35] offset:4096
  ds_write_b128 v4, v[36:39] offset:5120
  ds_write_b128 v4, v[40:43] offset:6144
  ds_write_b128 v4, v[44:47] offset:7168
  ds_write_b128 v4, v[48:51] offset:8192
  ds_write_b128 v4, v[52:55] offset:9216
  ds_write_b128 v4, v[56:59] offset:10240
  ds_write_b128 v4, v[60:63] offset:11264
  ds_write_b128 v4, v[64:67] offset:12288
  ds_write_b128 v4, v[68:71] offset:13312
  ds_write_b128 v4, v[72:75] offset:14336
  ds_write_b128 v4, v[76:79] offset:15360
  v_mov_b32 v128, v16
  v_mov_b32 v129, v17
  v_mov_b32 v130, v18
  v_mov_b32 v131, v19
  v_mov_b32 v132, v20
  v_mov_b32 v133, v21
  v_mov_b32 v134, v22
  v_mov_b32 v135, v23
  v_mov_b32 v136, v24
  v_mov_b32 v137, v25
  v_mov_b32 v138, v26
  v_mov_b32 v139, v27
  v_mov_b32 v140, v28
  v_mov_b32 v141, v29
  v_mov_b32 v142, v30
  v_mov_b32 v143, v31
k_red0_skip:
  s_cmp_lg_u32 s74, 1
  s_cbranch_scc1 k_red1_skip
  ds_write_b128 v4, v[16:19] offset:0
  ds_write_b128 v4, v[20:23] offset:1024
  ds_write_b128 v4, v[24:27] offset:2048
  ds_write_b128 v4, v[28:31] offset:3072
  ds_write_b128 v4, v[48:51] offset:8192
  ds_write_b128 v4, v[52:55] offset:9216
  ds_write_b128 v4, v[56:59] offset:10240
  ds_write_b128 v4, v[60:63] offset:11264
  ds_write_b128 v4, v[64:67] offset:12288
  ds_write_b128 v4, v[68:71] offset:13312
  ds_write_b128 v4, v[72:75] offset:14336
  ds_write_b128 v4, v[76:79] offset:15360
  v_mov_b32 v128, v32
  v_mov_b32 v129, v33
  v_mov_b32 v130, v34
  v_mov_b32 v131, v35
  v_mov_b32 v132, v36
  v_mov_b32 v133, v37
  v_mov_b32 v134, v38
  v_mov_b32 v135, v39
  v_mov_b32 v136, v40
  v_mov_b32 v137, v41
  v_mov_b32 v138, v42
  v_mov_b32 v139, v43
  v_mov_b32 v140, v44
  v_mov_b32 v141, v45
  v_mov_b32 v142, v46
  v_mov_b32 v143, v47
k_red1_skip:
  s_cmp_lg_u32 s74, 2
  s_cbranch_scc1 k_red2_skip
  ds_write_b128 v4, v[16:19] offset:0
  ds_write_b128 v4, v[20:23] offset:1024
  ds_write_b128 v4, v[24:27] offset:2048
  ds_write_b128 v4, v[28:31] offset:3072
  ds_write_b128 v4, v[32:35] offset:4096
  ds_write_b128 v4, v[36:39] offset:5120
  ds_write_b128 v4, v[40:43] offset:6144
  ds_write_b128 v4, v[44:47] offset:7168
  ds_write_b128 v4, v[64:67] offset:12288
  ds_write_b128 v4, v[68:71] offset:13312
  ds_write_b128 v4, v[72:75] offset:14336
  ds_write_b128 v4, v[76:79] offset:15360
  v_mov_b32 v128, v48
  v_mov_b32 v129, v49
  v_mov_b32 v130, v50
  v_mov_b32 v131, v51
  v_mov_b32 v132, v52
  v_mov_b32 v133, v53
  v_mov_b32 v134, v54
  v_mov_b32 v135, v55
  v_mov_b32 v136, v56
  v_mov_b32 v137, v57
  v_mov_b32 v138, v58
  v_mov_b32 v139, v59
  v_mov_b32 v140, v60
  v_mov_b32 v141, v61
  v_mov_b32 v142, v62
  v_mov_b32 v143, v63
k_red2_skip:
  s_cmp_lg_u32 s74, 3
  s_cbranch_scc1 k_red3_skip
  ds_write_b128 v4, v[16:19] offset:0
  ds_write_b128 v4, v[20:23] offset:1024
  ds_write_b128 v4, v[24:27] offset:2048
  ds_write_b128 v4, v[28:31] offset:3072
  ds_write_b128 v4, v[32:35] offset:4096
  ds_write_b128 v4, v[36:39] offset:5120
  ds_write_b128 v4, v[40:43] offset:6144
  ds_write_b128 v4, v[44:47] offset:7168
  ds_write_b128 v4, v[48:51] offset:8192
  ds_write_b128 v4, v[52:55] offset:9216
  ds_write_b128 v4, v[56:59] offset:10240
  ds_write_b128 v4, v[60:63] offset:11264
  v_mov_b32 v128, v64
  v_mov_b32 v129, v65
  v_mov_b32 v130, v66
  v_mov_b32 v131, v67
  v_mov_b32 v132, v68
  v_mov_b32 v133, v69
  v_mov_b32 v134, v70
  v_mov_b32 v135, v71
  v_mov_b32 v136, v72
  v_mov_b32 v137, v73
  v_mov_b32 v138, v74
  v_mov_b32 v139, v75
  v_mov_b32 v140, v76
  v_mov_b32 v141, v77
  v_mov_b32 v142, v78
  v_mov_b32 v143, v79
k_red3_skip:
  v_mov_b32 v8, 36880
  v_mov_b32 v9, 1
  s_mov_b64 exec, 1
  ds_add_u32 v8, v9
  s_mov_b64 exec, -1
  s_lshr_b32 s3, s74, 1
  s_lshl_b32 s3, s3, 5
  s_lshl_b32 s79, s4, 6
  s_add_u32 s3, s3, s79
  s_mul_i32 s3, s3, 896
  s_lshl_b32 s79, s5, 7
  s_add_u32 s3, s3, s79
  s_and_b32 s79, s74, 1
  s_lshl_b32 s79, s79, 6
  s_add_u32 s79, s3, s79
  v_mul_u32_u24 v4, 896, v2
  v_lshrrev_b32 v6, 5, v0
  v_lshl_add_u32 v4, v6, 4, v4
  v_mov_b32 v8, 36880
  s_mov_b32 s14, 0
lw_87:
  ds_read_b32 v9, v8
  s_add_u32 s14, s14, 1
  s_waitcnt lgkmcnt(0)
  v_readfirstlane_b32 s15, v9
  s_cmp_gt_u32 s14, 0x200000
  s_cbranch_scc1 lwe_88
  s_cmp_ge_u32 s15, 4
  s_cbranch_scc1 lwe_88
  s_branch lw_87
lwe_88:
  s_add_u32 s3, s74, 1
  s_and_b32 s3, s3, 3
  s_mul_i32 s3, s3, 24576
  v_add_u32 v6, s3, v5
  ds_read_b128 v[80:83], v6 offset:0
  ds_read_b128 v[84:87], v6 offset:1024
  ds_read_b128 v[88:91], v6 offset:2048
  ds_read_b128 v[92:95], v6 offset:3072
  s_add_u32 s3, s74, 2
  s_and_b32 s3, s3, 3
  s_mul_i32 s3, s3, 24576
  v_add_u32 v6, s3, v5
  ds_read_b128 v[96:99], v6 offset:0
  ds_read_b128 v[100:103], v6 offset:1024
  ds_read_b128 v[104:107], v6 offset:2048
  ds_read_b128 v[108:111], v6 offset:3072
  s_add_u32 s3, s74, 3
  s_and_b32 s3, s3, 3
  s_mul_i32 s3, s3, 24576
  v_add_u32 v6, s3, v5
  ds_read_b128 v[112:115], v6 offset:0
  ds_read_b128 v[116:119], v6 offset:1024
  ds_read_b128 v[120:123], v6 offset:2048
  ds_read_b128 v[124:127], v6 offset:3072
  s_waitcnt lgkmcnt(8)
  v_pk_add_f32 v[128:129], v[128:129], v[80:81]
  v_pk_add_f32 v[130:131], v[130:131], v[82:83]
  v_pk_add_f32 v[132:133], v[132:133], v[84:85]
  v_pk_add_f32 v[134:135], v[134:135], v[86:87]
  v_pk_add_f32 v[136:137], v[136:137], v[88:89]
  v_pk_add_f32 v[138:139], v[138:139], v[90:91]
  v_pk_add_f32 v[140:141], v[140:141], v[92:93]
  v_pk_add_f32 v[142:143], v[142:143], v[94:95]
  s_waitcnt lgkmcnt(4)
  v_pk_add_f32 v[128:129], v[128:129], v[96:97]
  v_pk_add_f32 v[130:131], v[130:131], v[98:99]
  v_pk_add_f32 v[132:133], v[132:133], v[100:101]
  v_pk_add_f32 v[134:135], v[134:135], v[102:103]
  v_pk_add_f32 v[136:137], v[136:137], v[104:105]
  v_pk_add_f32 v[138:139], v[138:139], v[106:107]
  v_pk_add_f32 v[140:141], v[140:141], v[108:109]
  v_pk_add_f32 v[142:143], v[142:143], v[110:111]
  s_waitcnt lgkmcnt(0)
  v_pk_add_f32 v[128:129], v[128:129], v[112:113]
  v_pk_add_f32 v[130:131], v[130:131], v[114:115]
  v_pk_add_f32 v[132:133], v[132:133], v[116:117]
  v_pk_add_f32 v[134:135], v[134:135], v[118:119]
  v_pk_add_f32 v[136:137], v[136:137], v[120:121]
  v_pk_add_f32 v[138:139], v[138:139], v[122:123]
  v_pk_add_f32 v[140:141], v[140:141], v[124:125]
  v_pk_add_f32 v[142:143], v[142:143], v[126:127]
  v_cvt_pk_bf16_f32 v16, v128, v129
  v_cvt_pk_bf16_f32 v17, v130, v131
  v_cvt_pk_bf16_f32 v18, v132, v133
  v_cvt_pk_bf16_f32 v19, v134, v135
  v_cvt_pk_bf16_f32 v20, v136, v137
  v_cvt_pk_bf16_f32 v21, v138, v139
  v_cvt_pk_bf16_f32 v22, v140, v141
  v_cvt_pk_bf16_f32 v23, v142, v143
  s_nop 1
  v_permlane32_swap_b32 v16, v18
  v_permlane32_swap_b32 v17, v19
  v_permlane32_swap_b32 v20, v22
  v_permlane32_swap_b32 v21, v23
  buffer_store_dwordx4 v[16:19], v4, s[60:63], s79 offen
  buffer_store_dwordx4 v[20:23], v4, s[60:63], s79 offen offset:32
k_f_done:
  s_endpgm
k_end:
  s_endpgm
k_code_end:
.section .rodata,"a"
.p2align 6
.amdhsa_kernel gated_mix__softmax_full_mha__dense_activation_silu__prompt_kernel
  .amdhsa_next_free_vgpr 256
  .amdhsa_next_free_sgpr 102
  .amdhsa_accum_offset 256
  .amdhsa_group_segment_fixed_size 0
  .amdhsa_kernarg_size 80
  .amdhsa_user_sgpr_count 2
  .amdhsa_user_sgpr_kernarg_segment_ptr 1
  .amdhsa_system_sgpr_workgroup_id_x 1
.end_amdhsa_kernel
```
